```python
import torch

def _softmax(x, axis=-1):
    return torch.softmax(x, dim=axis)
def _gelu(x):
    return torch.nn.functional.gelu(x, approximate="tanh")
def _silu(x):
    return torch.nn.functional.silu(x)
def _sigmoid(x):
    return torch.sigmoid(x)
def _layernorm(x, axis=-1, eps=1e-5):
    m = x.mean(dim=axis, keepdim=True)
    v = x.var(dim=axis, keepdim=True, unbiased=False)
    return (x - m) / torch.sqrt(v + eps)
def _scatter_add(tgt, idx, src, axis=0):
    return tgt.clone().index_add_(axis, idx, src)
def _segment_sum(src, seg, n):
    out = torch.zeros((n,) + src.shape[1:], dtype=src.dtype)
    return out.index_add_(0, seg, src)
def _pad(x, pw):
    flat = tuple(v for pair in reversed(pw) for v in pair)
    return torch.nn.functional.pad(x, flat)

kernel_name = 'sequential_preLN__ssm_conv_s4d__glu_gated_swiglu__prompt'

def setup_inputs():

    _w = (lambda a: (lambda t: t.to(torch.bfloat16) if t.is_floating_point() else t)(torch.as_tensor(a)))
    def _A_setup():
        Bsz, L, D, N = 1, 2048, 640, 128
        return {
            "u": _w((lambda *s: torch.randn(*s, dtype=torch.bfloat16) * 0.05)(Bsz, L, D)),
            "log_A_real": _w((lambda *s: torch.randn(*s, dtype=torch.bfloat16) * 6.4)(D, N) * 0.5),
            "A_imag": _w((lambda *s: torch.randn(*s, dtype=torch.bfloat16) * 0.05)(D, N) * 3.14),
            "C_real": _w((lambda *s: torch.randn(*s, dtype=torch.bfloat16) * 0.05)(D, N) / N ** 0.5),
            "C_imag": _w((lambda *s: torch.randn(*s, dtype=torch.bfloat16) * 0.05)(D, N) / N ** 0.5),
            "log_dt": _w((lambda *s: torch.randn(*s, dtype=torch.bfloat16) * 0.05)(D) * 0.5 - 4.0),
            "D_skip": _w((lambda *s: torch.randn(*s, dtype=torch.bfloat16) * 0.05)(D)),
        }
    _A_in = _A_setup()

    def _B_setup():
        B, S, D, F = 1, 2048, 640, 1728
        return {
            "x": _w((lambda *s: torch.randn(*s, dtype=torch.bfloat16) * 0.05)(B, S, D)),
            "w1": _w((lambda *s: torch.randn(*s, dtype=torch.bfloat16) * 0.4)(D, F) * (2.0 / D) ** 0.5),
            "w3": _w((lambda *s: torch.randn(*s, dtype=torch.bfloat16) * 0.4)(D, F) * (2.0 / D) ** 0.5),
            "w2": _w((lambda *s: torch.randn(*s, dtype=torch.bfloat16) * 0.4)(F, D) * (2.0 / F) ** 0.5),
        }
    _B_in = _B_setup()

    return {
        "A_u": _A_in["u"],
        "A_log_A_real": _A_in["log_A_real"],
        "A_A_imag": _A_in["A_imag"],
        "A_C_real": _A_in["C_real"],
        "A_C_imag": _A_in["C_imag"],
        "A_log_dt": _A_in["log_dt"],
        "A_D_skip": _A_in["D_skip"],
        "B_x": _B_in["x"],
        "B_w1": _B_in["w1"],
        "B_w3": _B_in["w3"],
        "B_w2": _B_in["w2"],
    }

def reference(A_u, A_log_A_real, A_A_imag, A_C_real, A_C_imag, A_log_dt, A_D_skip, B_x, B_w1, B_w3, B_w2):
    def _A_ref(u, log_A_real, A_imag, C_real, C_imag, log_dt, D_skip):
        L = u.shape[1]
        dt = torch.exp(log_dt)
        A = -torch.exp(log_A_real) + 1j * A_imag
        C = (C_real + 1j * C_imag) * dt[:, None]
        pos = (lambda x, dt: x.to(dt))(torch.arange(L), log_dt.dtype)
        P = torch.exp((A * dt[:, None])[:, :, None] * pos[None, None, :])
        K = 2.0 * torch.einsum("dn,dnl->dl", C, P).real
        L2 = 2 * L
        u_t = (lambda x, *d: x.permute(*d))(u, 0, 2, 1)
        Kf = (lambda x, *a, **k: torch.fft.rfft(x.float(), *a, **k))(K, L2)
        Uf = (lambda x, *a, **k: torch.fft.rfft(x.float(), *a, **k))(u_t, L2)
        y = (lambda x, *a, **k: torch.fft.irfft(x, *a, **k).to(torch.bfloat16))(Uf * Kf[None, :, :], L2)[:, :, :L]
        y = (lambda x, *d: x.permute(*d))(y, 0, 2, 1)
        return y + u * D_skip[None, None, :]

    def _B_ref(x, w1, w3, w2):
        gate = torch.einsum("bsd,df->bsf", x, w1)
        up = torch.einsum("bsd,df->bsf", x, w3)
        h = _silu(gate) * up
        out = torch.einsum("bsf,fd->bsd", h, w2)
        return out

    x = A_u
    h = x + _A_ref(_layernorm(x, axis=-1), A_log_A_real, A_A_imag, A_C_real, A_C_imag, A_log_dt, A_D_skip)
    h2 = h + _B_ref(_layernorm(h, axis=-1), B_w1, B_w3, B_w2)
    return h2
```

```asm
; @launch grid=(256,1,1) block=(512,1,1) lds=163840
.amdgcn_target "amdgcn-amd-amdhsa--gfx950"
.text
.globl sequential_preLN__ssm_conv_s4d__glu_gated_swiglu__prompt_kernel
.p2align 8
.type sequential_preLN__ssm_conv_s4d__glu_gated_swiglu__prompt_kernel,@function
sequential_preLN__ssm_conv_s4d__glu_gated_swiglu__prompt_kernel:
  s_cmp_ge_u32 s2, 256
  s_cbranch_scc1 LA_end
  s_load_dwordx16 s[4:19], s[0:1], 0
  s_load_dwordx8 s[20:27], s[0:1], 64
  s_load_dwordx4 s[28:31], s[0:1], 96
  v_lshrrev_b32 v2, 6, v0
  v_and_b32 v1, 63, v0
  v_readfirstlane_b32 s3, v2
  s_mov_b32 s80, 0x3f803f80
  s_mov_b32 s81, 0x3fb8aa3b
  s_mov_b32 s82, 0xffff0000
  s_lshl_b32 s72, s2, 3
  s_add_u32 s72, s72, s3
  s_mul_i32 s73, s72, 1280
  v_lshlrev_b32 v7, 3, v1
  v_lshlrev_b32 v8, 2, v1
  v_lshlrev_b32 v131, 7, v1
  v_mov_b32 v132, 1
  v_mov_b32 v133, 0x100
  v_mov_b32 v136, 0
  v_mov_b32 v137, 0
  v_mov_b32 v138, 0
  v_mov_b32 v139, 0
  s_sub_u32 s86, s2, 1
  s_waitcnt lgkmcnt(0)
  s_mov_b32 s32, s4
  s_mov_b32 s33, s5
  s_mov_b32 s34, 0x280000
  s_mov_b32 s35, 0x20000
  s_mov_b32 s36, s30
  s_mov_b32 s37, s31
  s_mov_b32 s38, 0x4000
  s_mov_b32 s39, 0x20000
  s_or_b32 s74, s2, s3
  s_cmp_lg_u32 s74, 0
  s_cbranch_scc1 LA_nz
  s_movk_i32 s75, 8192
  buffer_store_dwordx4 v[136:139], v131, s[36:39], 0 offen sc1
  buffer_store_dwordx4 v[136:139], v131, s[36:39], s75 offen sc1
LA_nz:
  buffer_load_dwordx2 v[170:171], v7, s[32:35], s73 offen
  buffer_load_dwordx2 v[172:173], v7, s[32:35], s73 offen offset:512
  buffer_load_dword v174, v8, s[32:35], s73 offen offset:1024
  s_mov_b32 s96, s28
  s_mov_b32 s97, s29
  s_mov_b32 s98, 0x100
  s_mov_b32 s99, 0x20000
  s_cmp_ge_u32 s86, 160
  s_cbranch_scc1 LA_i1
  s_and_b32 s84, s3, 3
  s_lshr_b32 s85, s3, 2
  s_lshl_b32 s62, s86, 2
  s_add_u32 s62, s62, s84
  s_lshl_b32 s63, s62, 8
  s_lshl_b32 s64, s62, 1
  v_lshlrev_b32 v33, 2, v1
  s_mov_b32 s40, s6
  s_mov_b32 s41, s7
  s_mov_b32 s42, 0x28000
  s_mov_b32 s43, 0x20000
  buffer_load_dword v28, v33, s[40:43], s63 offen
  s_mov_b32 s44, s8
  s_mov_b32 s45, s9
  s_mov_b32 s46, 0x28000
  s_mov_b32 s47, 0x20000
  buffer_load_dword v29, v33, s[44:47], s63 offen
  s_mov_b32 s48, s10
  s_mov_b32 s49, s11
  s_mov_b32 s50, 0x28000
  s_mov_b32 s51, 0x20000
  buffer_load_dword v30, v33, s[48:51], s63 offen
  s_mov_b32 s52, s12
  s_mov_b32 s53, s13
  s_mov_b32 s54, 0x28000
  s_mov_b32 s55, 0x20000
  buffer_load_dword v31, v33, s[52:55], s63 offen
  s_mov_b32 s56, s14
  s_mov_b32 s57, s15
  s_mov_b32 s58, 0x500
  s_mov_b32 s59, 0x20000
  buffer_load_ushort v32, off, s[56:59], s64
  s_mov_b32 s40, s16
  s_mov_b32 s41, s17
  s_mov_b32 s42, 0x500
  s_mov_b32 s43, 0x20000
  buffer_load_ushort v26, off, s[40:43], s64
  v_mul_u32_u24 v178, 80, v1
  s_lshl_b32 s75, s3, 3
  s_add_u32 s75, s75, 124032
  v_add_u32 v178, s75, v178
  v_lshrrev_b32 v179, 1, v1
  v_mul_u32_u24 v179, 80, v179
  v_and_b32 v180, 1, v1
  v_lshl_add_u32 v179, v180, 2, v179
  v_add_u32 v183, s75, v179
  v_lshrrev_b32 v179, 2, v0
  v_and_b32 v180, 3, v0
  v_and_b32 v181, 0xfc, v179
  v_add_u32 v181, v181, v180
  v_mul_u32_u24 v181, 80, v181
  v_and_b32 v182, 3, v179
  s_mov_b32 s87, 124032
  v_lshl_add_u32 v181, v182, 3, v181
  v_add_u32 v175, s87, v181
  v_lshlrev_b32 v180, 4, v180
  v_lshl_add_u32 v179, v179, 14, v180
  s_add_u32 s56, s30, 0x1800000
  s_addc_u32 s57, s31, 0
  s_mov_b32 s58, 0x500000
  s_mov_b32 s59, 0x20000
  v_and_b32 v2, 15, v1
  v_lshrrev_b32 v3, 4, v1
  s_mul_i32 s101, s3, 15504
  v_lshl_add_u32 v113, v1, 2, s101
  v_lshl_add_u32 v4, v3, 4, s101
  v_mul_u32_u24 v5, 272, v2
  v_add_u32 v202, v5, v4
  v_lshrrev_b32 v5, 2, v2
  v_and_b32 v6, 1, v2
  v_lshl_add_u32 v5, v5, 1, v6
  v_cmp_eq_u32 vcc, 2, v2
  s_nop 1
  v_cndmask_b32 v5, v5, 8, vcc
  v_mul_u32_u24 v5, 272, v5
  v_add_u32 v203, v5, v4
  s_xor_b32 s66, s3, 4
  s_mul_i32 s66, s66, 4160
  s_add_u32 s66, s66, 130560
  v_lshl_add_u32 v235, v1, 4, s66
  v_lshlrev_b32 v5, 3, v3
  v_lshl_add_u32 v5, v2, 5, v5
  v_add_u32 v236, s66, v5
  s_mul_i32 s66, s3, 4160
  s_add_u32 s66, s66, 130560
  v_lshl_add_u32 v234, v1, 4, s66
  s_mul_i32 s66, s84, 8320
  s_add_u32 s66, s66, 78720
  s_mul_i32 s67, s85, 4160
  s_add_u32 s67, s67, s66
  v_mov_b32 v208, s67
  v_lshl_add_u32 v207, v2, 2, s67
  v_lshlrev_b32 v4, 4, v2
  v_lshl_add_u32 v5, v3, 9, v4
  s_lshl_b32 s68, s85, 3
  s_sub_u32 s68, s67, s68
  s_add_u32 s68, s68, 1784
  v_sub_u32 v204, s68, v5
  v_lshl_add_u32 v5, v3, 8, v4
  s_lshl_b32 s68, s85, 2
  s_sub_u32 s68, s67, s68
  s_add_u32 s68, s68, 3060
  v_sub_u32 v205, s68, v5
  v_lshrrev_b32 v5, 1, v3
  v_lshl_add_u32 v5, v5, 8, v4
  v_and_b32 v7, 1, v3
  v_lshl_add_u32 v5, v7, 3, v5
  s_lshl_b32 s68, s85, 1
  s_sub_u32 s68, s67, s68
  s_add_u32 s68, s68, 3578
  v_sub_u32 v206, s68, v5
  s_lshl_b32 s68, s85, 6
  v_lshlrev_b32 v7, 4, v3
  v_lshrrev_b32 v5, 1, v2
  v_lshlrev_b32 v5, 2, v5
  v_sub_u32 v5, v7, v5
  v_mul_u32_u24 v6, 4160, v6
  v_sub_u32 v5, v5, v6
  s_sub_u32 s66, s66, s68
  s_add_u32 s69, s66, 7324
  v_add_u32 v229, s69, v5
  s_add_u32 s69, s66, 6300
  v_add_u32 v230, s69, v5
  s_add_u32 s69, s66, 5276
  v_add_u32 v231, s69, v5
  s_add_u32 s69, s66, 4252
  v_add_u32 v232, s69, v5
  s_mul_i32 s66, s84, 4640
  s_add_u32 s66, s66, 112000
  v_lshl_add_u32 v209, v1, 3, s66
  v_lshl_add_u32 v5, v2, 5, v7
  s_sub_u32 s66, s66, s68
  s_add_u32 s66, s66, 96
  v_add_u32 v228, s66, v5
  v_and_b32 v4, 3, v1
  v_lshlrev_b32 v5, 3, v4
  v_lshl_add_u32 v5, v3, 6, v5
  v_bfe_u32 v6, v1, 2, 2
  s_and_b32 s66, s3, 1
  s_lshl_b32 s66, s66, 8
  s_lshl_b32 s67, s85, 9
  s_add_u32 s66, s66, s67
  s_add_u32 s67, s3, 2
  s_bitcmp1_b32 s67, 2
  s_cselect_b32 s67, 0, 16640
  s_add_u32 s67, s67, s66
  s_add_u32 s67, s67, 130560
  v_mul_u32_u24 v7, 4160, v6
  v_add3_u32 v237, v7, v5, s67
  s_mul_i32 s66, s84, 4640
  s_add_u32 s66, s66, 112512
  v_lshlrev_b32 v5, 3, v3
  v_lshl_add_u32 v5, v2, 5, v5
  v_add_u32 v233, s66, v5
  v_lshrrev_b32 v5, 1, v3
  v_lshl_add_u32 v5, v2, 1, v5
  v_lshlrev_b32 v5, 6, v5
  v_and_b32 v7, 1, v3
  v_lshl_add_u32 v5, v7, 3, v5
  s_lshl_b32 s66, s84, 4
  v_add_u32 v210, s66, v5
  v_mul_u32_u24 v4, 4640, v4
  v_lshrrev_b32 v5, 2, v1
  v_lshl_add_u32 v4, v5, 4, v4
  s_lshl_b32 s66, s3, 9
  s_add_u32 s66, s66, 112512
  v_add_u32 v239, s66, v4
  v_lshlrev_b32 v211, 4, v1
  v_lshlrev_b32 v238, 4, v0
  s_lshl_b32 s100, s86, 14
  s_lshl_b32 s66, s3, 11
  s_add_u32 s90, s100, s66
  s_add_u32 s91, s100, 2621440
  s_lshr_b32 s78, s2, 3
  s_and_b32 s78, s78, 7
  s_lshl_b32 s78, s78, 7
  v_lshl_add_u32 v135, v1, 10, s78
  v_mov_b32 v246, v135
  v_mov_b32 v247, v131
  v_mov_b32 v248, 1
  v_mov_b32 v129, 154752
  ds_write_b32 v129, v136
  s_and_b32 s35, s2, 1
  s_lshl_b32 s32, s35, 3
  s_bfe_u32 s18, s2, 0x30003
  s_add_u32 s32, s32, s18
  s_bfe_u32 s33, s2, 0x20001
  s_lshl_b32 s33, s33, 2
  s_lshr_b32 s35, s2, 6
  s_add_u32 s33, s33, s35
  s_add_u32 s18, s18, s35
  s_and_b32 s18, s18, 3
  s_mul_i32 s18, s18, 0
  s_mul_i32 s34, s33, 27
  s_lshr_b32 s34, s34, 2
  s_mul_i32 s34, s34, 41984
  s_add_u32 s40, s30, 0x10000
  s_addc_u32 s41, s31, 0
  s_mov_b32 s42, 0x280000
  s_mov_b32 s43, 0x20000
  s_add_u32 s44, s30, 0x300000
  s_addc_u32 s45, s31, 0
  s_mov_b32 s46, 0x453000
  s_mov_b32 s47, 0x20000
  s_waitcnt vmcnt(6)
  v_dot2_f32_bf16 v176, v170, s80, 0
  v_dot2_f32_bf16 v177, v170, v170, 0
  v_dot2_f32_bf16 v176, v171, s80, v176
  v_dot2_f32_bf16 v177, v171, v171, v177
  v_dot2_f32_bf16 v176, v172, s80, v176
  v_dot2_f32_bf16 v177, v172, v172, v177
  v_dot2_f32_bf16 v176, v173, s80, v176
  v_dot2_f32_bf16 v177, v173, v173, v177
  v_dot2_f32_bf16 v176, v174, s80, v176
  v_dot2_f32_bf16 v177, v174, v174, v177
  ds_write_b32 v183, v174 offset:23040
  s_nop 0
  v_add_f32_dpp v176, v176, v176 row_ror:8 row_mask:0xf bank_mask:0xf
  v_add_f32_dpp v177, v177, v177 row_ror:8 row_mask:0xf bank_mask:0xf
  ds_write_b64 v178, v[170:171] offset:12800
  ds_write_b64 v178, v[172:173] offset:17920
  v_add_f32_dpp v176, v176, v176 row_ror:4 row_mask:0xf bank_mask:0xf
  v_add_f32_dpp v177, v177, v177 row_ror:4 row_mask:0xf bank_mask:0xf
  v_lshlrev_b32 v184, 16, v170
  v_and_b32 v185, s82, v170
  v_add_f32_dpp v176, v176, v176 row_ror:2 row_mask:0xf bank_mask:0xf
  v_add_f32_dpp v177, v177, v177 row_ror:2 row_mask:0xf bank_mask:0xf
  v_lshlrev_b32 v186, 16, v171
  v_and_b32 v187, s82, v171
  v_add_f32_dpp v176, v176, v176 row_ror:1 row_mask:0xf bank_mask:0xf
  v_add_f32_dpp v177, v177, v177 row_ror:1 row_mask:0xf bank_mask:0xf
  v_lshlrev_b32 v188, 16, v172
  v_and_b32 v189, s82, v172
  v_add_f32_dpp v176, v176, v176 row_bcast:15 row_mask:0xa bank_mask:0xf
  v_add_f32_dpp v177, v177, v177 row_bcast:15 row_mask:0xa bank_mask:0xf
  v_lshlrev_b32 v190, 16, v173
  v_and_b32 v191, s82, v173
  v_add_f32_dpp v176, v176, v176 row_bcast:31 row_mask:0xc bank_mask:0xf
  v_add_f32_dpp v177, v177, v177 row_bcast:31 row_mask:0xc bank_mask:0xf
  v_lshlrev_b32 v192, 16, v174
  v_and_b32 v193, s82, v174
  v_mul_f32 v176, 0x3acccccd, v176
  v_mul_f32 v177, 0x3acccccd, v177
  v_fma_f32 v177, -v176, v176, v177
  v_cvt_pk_bf16_f32 v176, 0, v176
  v_max_f32 v177, 0, v177
  v_readlane_b32 s76, v176, 63
  v_cvt_pk_bf16_f32 v177, 0, v177
  v_add_f32 v177, 0x3727c5ac, v177
  v_pk_add_f32 v[184:185], v[184:185], s[76:77] op_sel_hi:[1,0] neg_lo:[0,1] neg_hi:[0,1]
  v_cvt_pk_bf16_f32 v177, 0, v177
  v_cvt_pk_bf16_f32 v184, 0, v184
  v_sqrt_f32 v177, v177
  v_cvt_pk_bf16_f32 v185, 0, v185
  v_pk_add_f32 v[186:187], v[186:187], s[76:77] op_sel_hi:[1,0] neg_lo:[0,1] neg_hi:[0,1]
  v_pk_add_f32 v[188:189], v[188:189], s[76:77] op_sel_hi:[1,0] neg_lo:[0,1] neg_hi:[0,1]
  v_cvt_pk_bf16_f32 v177, 0, v177
  v_cvt_pk_bf16_f32 v186, 0, v186
  v_rcp_f32 v177, v177
  v_cvt_pk_bf16_f32 v187, 0, v187
  v_cvt_pk_bf16_f32 v188, 0, v188
  v_cvt_pk_bf16_f32 v189, 0, v189
  v_readlane_b32 s78, v177, 63
  v_pk_add_f32 v[190:191], v[190:191], s[76:77] op_sel_hi:[1,0] neg_lo:[0,1] neg_hi:[0,1]
  v_pk_add_f32 v[192:193], v[192:193], s[76:77] op_sel_hi:[1,0] neg_lo:[0,1] neg_hi:[0,1]
  v_cvt_pk_bf16_f32 v190, 0, v190
  v_cvt_pk_bf16_f32 v191, 0, v191
  v_cvt_pk_bf16_f32 v192, 0, v192
  v_cvt_pk_bf16_f32 v193, 0, v193
  v_pk_mul_f32 v[184:185], v[184:185], s[78:79] op_sel_hi:[1,0]
  v_pk_mul_f32 v[186:187], v[186:187], s[78:79] op_sel_hi:[1,0]
  v_cvt_pk_bf16_f32 v184, 0, v184
  v_cvt_pk_bf16_f32 v185, 0, v185
  v_cvt_pk_bf16_f32 v186, 0, v186
  v_cvt_pk_f16_f32 v196, v184, v185
  v_cvt_pk_bf16_f32 v187, 0, v187
  v_pk_mul_f32 v[188:189], v[188:189], s[78:79] op_sel_hi:[1,0]
  v_cvt_pk_f16_f32 v197, v186, v187
  v_cvt_pk_bf16_f32 v188, 0, v188
  ds_write_b64 v178, v[196:197] offset:0
  v_cvt_pk_bf16_f32 v189, 0, v189
  v_pk_mul_f32 v[190:191], v[190:191], s[78:79] op_sel_hi:[1,0]
  v_cvt_pk_f16_f32 v198, v188, v189
  v_cvt_pk_bf16_f32 v190, 0, v190
  v_cvt_pk_bf16_f32 v191, 0, v191
  v_pk_mul_f32 v[192:193], v[192:193], s[78:79] op_sel_hi:[1,0]
  v_cvt_pk_f16_f32 v199, v190, v191
  v_cvt_pk_bf16_f32 v192, 0, v192
  ds_write_b64 v178, v[198:199] offset:5120
  v_cvt_pk_bf16_f32 v193, 0, v193
  v_cvt_pk_f16_f32 v200, v192, v193
  ds_write_b32 v183, v200 offset:10240
  s_lshl_b32 s74, s2, 6
  s_add_u32 s75, s74, 2621440
  s_add_u32 s76, s74, 2097152
  s_add_u32 s77, s74, 4194304
  s_waitcnt lgkmcnt(0)
  s_barrier
  ds_read_b64_tr_b16 v[184:185], v175 offset:0
  ds_read_b64_tr_b16 v[186:187], v175 offset:32
  s_cmp_ge_u32 s3, 2
  s_cbranch_scc1 LA_u1
  ds_read_b64_tr_b16 v[192:193], v175 offset:10240
  ds_read_b64_tr_b16 v[194:195], v175 offset:10272
  ds_read_b64_tr_b16 v[188:189], v175 offset:12800
  ds_read_b64_tr_b16 v[190:191], v175 offset:12832
  s_waitcnt lgkmcnt(4)
  buffer_store_dwordx4 v[184:187], v179, s[56:59], s74 offen sc1
  s_waitcnt lgkmcnt(2)
  buffer_store_dwordx4 v[192:195], v179, s[56:59], s76 offen sc1
  s_cmp_lg_u32 s3, 0
  s_cbranch_scc1 LA_u0
  buffer_load_dword v130, off, s[96:99], 0 sc1
  s_waitcnt lgkmcnt(0)
  buffer_store_dwordx4 v[188:191], v179, s[56:59], s75 offen sc1
  s_waitcnt vmcnt(4)
  s_branch LA_u3
LA_u0:
  s_waitcnt lgkmcnt(0)
  buffer_store_dwordx4 v[188:191], v179, s[56:59], s75 offen sc1
  s_waitcnt vmcnt(3)
  s_branch LA_u3
LA_u1:
  ds_read_b64_tr_b16 v[188:189], v175 offset:12800
  ds_read_b64_tr_b16 v[190:191], v175 offset:12832
  s_cmp_ge_u32 s3, 4
  s_cbranch_scc1 LA_u2
  ds_read_b64_tr_b16 v[192:193], v175 offset:20480
  ds_read_b64_tr_b16 v[194:195], v175 offset:20512
  s_waitcnt lgkmcnt(4)
  buffer_store_dwordx4 v[184:187], v179, s[56:59], s74 offen sc1
  s_waitcnt lgkmcnt(2)
  buffer_store_dwordx4 v[188:191], v179, s[56:59], s75 offen sc1
  s_waitcnt lgkmcnt(0)
  buffer_store_dwordx4 v[192:195], v179, s[56:59], s77 offen sc1
  s_waitcnt vmcnt(3)
  s_branch LA_u3
LA_u2:
  s_waitcnt lgkmcnt(2)
  buffer_store_dwordx4 v[184:187], v179, s[56:59], s74 offen sc1
  s_waitcnt lgkmcnt(0)
  buffer_store_dwordx4 v[188:191], v179, s[56:59], s75 offen sc1
  s_waitcnt vmcnt(2)
LA_u3:
  s_lshl_b32 s62, s85, 4
  v_and_b32 v102, 0x7fff7fff, v30
  s_sub_u32 s62, 16, s62
  v_and_b32 v103, 0x7fff7fff, v31
  v_lshlrev_b32 v28, s62, v28
  v_pk_max_u16 v102, v102, v103
  v_and_b32 v28, s82, v28
  v_lshrrev_b32 v103, 16, v102
  v_and_b32 v102, 0xffff, v102
  v_lshlrev_b32 v29, s62, v29
  v_max_u32 v102, v102, v103
  v_and_b32 v29, s82, v29
  v_lshlrev_b32 v30, s62, v30
  v_max_u32_dpp v102, v102, v102 row_ror:8 row_mask:0xf bank_mask:0xf
  v_and_b32 v30, s82, v30
  v_lshlrev_b32 v31, s62, v31
  v_max_u32_dpp v102, v102, v102 row_ror:4 row_mask:0xf bank_mask:0xf
  v_and_b32 v31, s82, v31
  v_lshlrev_b32 v32, 16, v32
  v_max_u32_dpp v102, v102, v102 row_ror:2 row_mask:0xf bank_mask:0xf
  v_mul_f32 v32, s81, v32
  v_mul_f32 v28, s81, v28
  v_max_u32_dpp v102, v102, v102 row_ror:1 row_mask:0xf bank_mask:0xf
  v_exp_f32 v32, v32
  v_exp_f32 v28, v28
  v_max_u32_dpp v102, v102, v102 row_bcast:15 row_mask:0xa bank_mask:0xf
  v_mov_b32 v106, 0x3e22f983
  v_cvt_pk_bf16_f32 v32, 0, v32
  v_max_u32_dpp v102, v102, v102 row_bcast:31 row_mask:0xc bank_mask:0xf
  v_cvt_pk_bf16_f32 v28, 0, v28
  v_readlane_b32 s64, v102, 63
  v_mul_f32 v28, v28, v32
  v_mul_f32 v29, v29, v32
  v_mul_f32 v28, 0xbfb8aa3b, v28
  v_mul_f32 v104, 0x3e22f983, v29
  s_lshr_b32 s64, s64, 7
  v_fma_f32 v105, v29, v106, -v104
  s_sub_u32 s65, 126, s64
  v_fmac_f32 v105, 0x31dc9c88, v29
  s_sub_u32 s64, s64, 125
  v_ldexp_f32 v82, v30, s65
  v_ldexp_f32 v83, v31, s65
  v_ldexp_f32 v240, v32, s64
  v_exp_f32 v107, v28
  v_fract_f32 v108, v104
  v_mul_f32 v109, 0x41000000, v28
  v_add_f32 v108, v108, v105
  v_exp_f32 v109, v109
  v_cos_f32 v34, v108
  v_sin_f32 v35, v108
  v_mul_f32 v110, 0x41000000, v104
  v_mul_f32 v111, 0x43000000, v28
  v_mul_f32 v34, v34, v107
  v_mul_f32 v35, v35, v107
  v_fract_f32 v110, v110
  v_exp_f32 v111, v111
  v_fmac_f32 v110, 0x41000000, v105
  v_mul_f32 v112, 0x43000000, v104
  v_cos_f32 v80, v110
  v_sin_f32 v81, v110
  v_fract_f32 v112, v112
  v_mov_b32 v114, 0x3c00
  v_mul_f32 v80, v80, v109
  v_mul_f32 v81, v81, v109
  v_fmac_f32 v112, 0x43000000, v105
  ds_write_b32 v113, v114 offset:0
  v_cos_f32 v48, v112
  v_sin_f32 v49, v112
  v_cvt_pk_f16_f32 v95, v82, -v83
  v_cvt_pk_f16_f32 v96, v34, v35
  v_mul_f32 v48, v48, v111
  v_mul_f32 v49, v49, v111
  v_pk_mul_f32 v[84:85], v[82:83], v[80:81] op_sel:[0,0] op_sel_hi:[0,1]
  v_cvt_pk_f16_f32 v94, v48, v49
  v_pk_mul_f32 v[50:51], v[48:49], v[48:49] op_sel:[0,0] op_sel_hi:[0,1]
  ds_write_b32 v113, v94 offset:2176
  ds_write_b32 v113, v95 offset:11152
  ds_write_b32 v113, v96 offset:272
  v_pk_fma_f32 v[50:51], v[48:49], v[48:49], v[50:51] op_sel:[1,1,0] op_sel_hi:[1,0,1] neg_lo:[1,0,0]
  v_pk_fma_f32 v[84:85], v[82:83], v[80:81], v[84:85] op_sel:[1,1,0] op_sel_hi:[1,0,1] neg_lo:[1,0,0]
  v_cvt_pk_f16_f32 v97, v50, v51
  v_cvt_pk_f16_f32 v98, v84, -v85
  ds_write_b32 v113, v97 offset:4352
  ds_write_b32 v113, v98 offset:11424
  v_pk_mul_f32 v[36:37], v[34:35], v[34:35] op_sel:[0,0] op_sel_hi:[0,1]
  v_pk_mul_f32 v[52:53], v[50:51], v[48:49] op_sel:[0,0] op_sel_hi:[0,1]
  v_pk_fma_f32 v[36:37], v[34:35], v[34:35], v[36:37] op_sel:[1,1,0] op_sel_hi:[1,0,1] neg_lo:[1,0,0]
  v_pk_fma_f32 v[52:53], v[50:51], v[48:49], v[52:53] op_sel:[1,1,0] op_sel_hi:[1,0,1] neg_lo:[1,0,0]
  v_cvt_pk_f16_f32 v99, v36, v37
  v_cvt_pk_f16_f32 v100, v52, v53
  ds_write_b32 v113, v99 offset:544
  ds_write_b32 v113, v100 offset:6528
  v_pk_mul_f32 v[82:83], v[84:85], v[80:81] op_sel:[0,0] op_sel_hi:[0,1]
  v_pk_mul_f32 v[38:39], v[36:37], v[34:35] op_sel:[0,0] op_sel_hi:[0,1]
  v_pk_fma_f32 v[82:83], v[84:85], v[80:81], v[82:83] op_sel:[1,1,0] op_sel_hi:[1,0,1] neg_lo:[1,0,0]
  v_pk_fma_f32 v[38:39], v[36:37], v[34:35], v[38:39] op_sel:[1,1,0] op_sel_hi:[1,0,1] neg_lo:[1,0,0]
  v_cvt_pk_f16_f32 v101, v82, -v83
  v_cvt_pk_f16_f32 v94, v38, v39
  ds_write_b32 v113, v101 offset:11696
  ds_write_b32 v113, v94 offset:816
  v_pk_mul_f32 v[54:55], v[50:51], v[50:51] op_sel:[0,0] op_sel_hi:[0,1]
  v_pk_mul_f32 v[84:85], v[82:83], v[80:81] op_sel:[0,0] op_sel_hi:[0,1]
  v_pk_fma_f32 v[54:55], v[50:51], v[50:51], v[54:55] op_sel:[1,1,0] op_sel_hi:[1,0,1] neg_lo:[1,0,0]
  v_pk_fma_f32 v[84:85], v[82:83], v[80:81], v[84:85] op_sel:[1,1,0] op_sel_hi:[1,0,1] neg_lo:[1,0,0]
  v_cvt_pk_f16_f32 v95, v54, v55
  v_cvt_pk_f16_f32 v96, v84, -v85
  ds_write_b32 v113, v95 offset:4896
  ds_write_b32 v113, v96 offset:11968
  v_pk_mul_f32 v[40:41], v[36:37], v[36:37] op_sel:[0,0] op_sel_hi:[0,1]
  v_pk_mul_f32 v[56:57], v[54:55], v[48:49] op_sel:[0,0] op_sel_hi:[0,1]
  v_pk_fma_f32 v[40:41], v[36:37], v[36:37], v[40:41] op_sel:[1,1,0] op_sel_hi:[1,0,1] neg_lo:[1,0,0]
  v_pk_fma_f32 v[56:57], v[54:55], v[48:49], v[56:57] op_sel:[1,1,0] op_sel_hi:[1,0,1] neg_lo:[1,0,0]
  v_cvt_pk_f16_f32 v97, v40, v41
  v_cvt_pk_f16_f32 v98, v56, v57
  ds_write_b32 v113, v97 offset:1088
  ds_write_b32 v113, v98 offset:5984
  v_pk_mul_f32 v[82:83], v[84:85], v[80:81] op_sel:[0,0] op_sel_hi:[0,1]
  v_pk_mul_f32 v[42:43], v[40:41], v[34:35] op_sel:[0,0] op_sel_hi:[0,1]
  v_pk_fma_f32 v[82:83], v[84:85], v[80:81], v[82:83] op_sel:[1,1,0] op_sel_hi:[1,0,1] neg_lo:[1,0,0]
  v_pk_fma_f32 v[42:43], v[40:41], v[34:35], v[42:43] op_sel:[1,1,0] op_sel_hi:[1,0,1] neg_lo:[1,0,0]
  v_cvt_pk_f16_f32 v99, v82, -v83
  v_cvt_pk_f16_f32 v100, v42, v43
  ds_write_b32 v113, v99 offset:12240
  ds_write_b32 v113, v100 offset:1360
  v_pk_mul_f32 v[58:59], v[54:55], v[50:51] op_sel:[0,0] op_sel_hi:[0,1]
  v_pk_mul_f32 v[84:85], v[82:83], v[80:81] op_sel:[0,0] op_sel_hi:[0,1]
  v_pk_fma_f32 v[58:59], v[54:55], v[50:51], v[58:59] op_sel:[1,1,0] op_sel_hi:[1,0,1] neg_lo:[1,0,0]
  v_pk_fma_f32 v[84:85], v[82:83], v[80:81], v[84:85] op_sel:[1,1,0] op_sel_hi:[1,0,1] neg_lo:[1,0,0]
  v_cvt_pk_f16_f32 v101, v58, v59
  v_cvt_pk_f16_f32 v94, v84, -v85
  ds_write_b32 v113, v101 offset:7072
  ds_write_b32 v113, v94 offset:12512
  v_pk_mul_f32 v[44:45], v[40:41], v[36:37] op_sel:[0,0] op_sel_hi:[0,1]
  v_pk_mul_f32 v[60:61], v[54:55], v[52:53] op_sel:[0,0] op_sel_hi:[0,1]
  v_pk_fma_f32 v[44:45], v[40:41], v[36:37], v[44:45] op_sel:[1,1,0] op_sel_hi:[1,0,1] neg_lo:[1,0,0]
  v_pk_fma_f32 v[60:61], v[54:55], v[52:53], v[60:61] op_sel:[1,1,0] op_sel_hi:[1,0,1] neg_lo:[1,0,0]
  v_cvt_pk_f16_f32 v95, v44, v45
  v_cvt_pk_f16_f32 v96, v60, v61
  s_and_b32 s78, s3, 6
  s_cmp_eq_u32 s78, 2
  s_cbranch_scc1 LS_wc
  s_waitcnt vmcnt(1)
LS_wc:
  s_waitcnt vmcnt(2)
  s_barrier
  s_cmp_lg_u32 s3, 0
  s_cbranch_scc1 LS_skipc
  s_mov_b32 s79, 0
LS_goc:
  v_readfirstlane_b32 s78, v130
  s_cmp_eq_u32 s78, 1
  s_cbranch_scc1 LS_okc
  buffer_load_dword v130, off, s[96:99], 0 sc1
  s_add_u32 s79, s79, 1
  s_cmp_lt_u32 s79, 100000
  s_waitcnt vmcnt(0)
  s_cbranch_scc1 LS_goc
LS_okc:
  s_and_b32 s78, s2, 15
  s_lshl_b32 s78, s78, 10
  s_mov_b64 exec, 255
  buffer_atomic_add v132, v131, s[36:39], s78 offen offset:0 sc1
  s_mov_b64 exec, -1
LS_skipc:
  ds_write_b32 v113, v95 offset:1632
  ds_write_b32 v113, v96 offset:8160
  v_pk_mul_f32 v[82:83], v[84:85], v[80:81] op_sel:[0,0] op_sel_hi:[0,1]
  v_pk_mul_f32 v[46:47], v[40:41], v[38:39] op_sel:[0,0] op_sel_hi:[0,1]
  v_pk_fma_f32 v[82:83], v[84:85], v[80:81], v[82:83] op_sel:[1,1,0] op_sel_hi:[1,0,1] neg_lo:[1,0,0]
  v_pk_fma_f32 v[46:47], v[40:41], v[38:39], v[46:47] op_sel:[1,1,0] op_sel_hi:[1,0,1] neg_lo:[1,0,0]
  v_cvt_pk_f16_f32 v97, v82, -v83
  v_cvt_pk_f16_f32 v98, v46, v47
  ds_write_b32 v113, v97 offset:12784
  ds_write_b32 v113, v98 offset:1904
  v_pk_mul_f32 v[62:63], v[54:55], v[54:55] op_sel:[0,0] op_sel_hi:[0,1]
  v_pk_mul_f32 v[84:85], v[82:83], v[80:81] op_sel:[0,0] op_sel_hi:[0,1]
  v_pk_fma_f32 v[62:63], v[54:55], v[54:55], v[62:63] op_sel:[1,1,0] op_sel_hi:[1,0,1] neg_lo:[1,0,0]
  v_pk_fma_f32 v[84:85], v[82:83], v[80:81], v[84:85] op_sel:[1,1,0] op_sel_hi:[1,0,1] neg_lo:[1,0,0]
  v_cvt_pk_f16_f32 v99, v62, v63
  v_cvt_pk_f16_f32 v100, v84, -v85
  ds_write_b32 v113, v99 offset:8704
  ds_write_b32 v113, v100 offset:13056
  v_pk_mul_f32 v[86:87], v[48:49], v[34:35] op_sel:[0,0] op_sel_hi:[0,1]
  v_pk_mul_f32 v[64:65], v[62:63], v[48:49] op_sel:[0,0] op_sel_hi:[0,1]
  v_pk_fma_f32 v[86:87], v[48:49], v[34:35], v[86:87] op_sel:[1,1,0] op_sel_hi:[1,0,1] neg_lo:[1,0,0]
  v_pk_fma_f32 v[64:65], v[62:63], v[48:49], v[64:65] op_sel:[1,1,0] op_sel_hi:[1,0,1] neg_lo:[1,0,0]
  v_cvt_pk_f16_f32 v101, v86, v87
  v_cvt_pk_f16_f32 v94, v64, v65
  ds_write_b32 v113, v101 offset:2448
  ds_write_b32 v113, v94 offset:8976
  v_pk_mul_f32 v[82:83], v[84:85], v[80:81] op_sel:[0,0] op_sel_hi:[0,1]
  v_pk_mul_f32 v[88:89], v[48:49], v[36:37] op_sel:[0,0] op_sel_hi:[0,1]
  v_pk_fma_f32 v[82:83], v[84:85], v[80:81], v[82:83] op_sel:[1,1,0] op_sel_hi:[1,0,1] neg_lo:[1,0,0]
  v_pk_fma_f32 v[88:89], v[48:49], v[36:37], v[88:89] op_sel:[1,1,0] op_sel_hi:[1,0,1] neg_lo:[1,0,0]
  v_cvt_pk_f16_f32 v95, v82, -v83
  v_cvt_pk_f16_f32 v96, v88, v89
  ds_write_b32 v113, v95 offset:13328
  ds_write_b32 v113, v96 offset:2720
  v_pk_mul_f32 v[66:67], v[62:63], v[50:51] op_sel:[0,0] op_sel_hi:[0,1]
  v_pk_mul_f32 v[84:85], v[82:83], v[80:81] op_sel:[0,0] op_sel_hi:[0,1]
  v_pk_fma_f32 v[66:67], v[62:63], v[50:51], v[66:67] op_sel:[1,1,0] op_sel_hi:[1,0,1] neg_lo:[1,0,0]
  v_pk_fma_f32 v[84:85], v[82:83], v[80:81], v[84:85] op_sel:[1,1,0] op_sel_hi:[1,0,1] neg_lo:[1,0,0]
  v_cvt_pk_f16_f32 v97, v66, v67
  v_cvt_pk_f16_f32 v98, v84, -v85
  ds_write_b32 v113, v97 offset:9248
  ds_write_b32 v113, v98 offset:13600
  v_pk_mul_f32 v[90:91], v[48:49], v[38:39] op_sel:[0,0] op_sel_hi:[0,1]
  v_pk_mul_f32 v[68:69], v[62:63], v[52:53] op_sel:[0,0] op_sel_hi:[0,1]
  v_pk_fma_f32 v[90:91], v[48:49], v[38:39], v[90:91] op_sel:[1,1,0] op_sel_hi:[1,0,1] neg_lo:[1,0,0]
  v_pk_fma_f32 v[68:69], v[62:63], v[52:53], v[68:69] op_sel:[1,1,0] op_sel_hi:[1,0,1] neg_lo:[1,0,0]
  v_cvt_pk_f16_f32 v99, v90, v91
  v_cvt_pk_f16_f32 v100, v68, v69
  ds_write_b32 v113, v99 offset:2992
  ds_write_b32 v113, v100 offset:9520
  v_pk_mul_f32 v[82:83], v[84:85], v[80:81] op_sel:[0,0] op_sel_hi:[0,1]
  v_pk_mul_f32 v[92:93], v[48:49], v[40:41] op_sel:[0,0] op_sel_hi:[0,1]
  v_pk_fma_f32 v[82:83], v[84:85], v[80:81], v[82:83] op_sel:[1,1,0] op_sel_hi:[1,0,1] neg_lo:[1,0,0]
  v_pk_fma_f32 v[92:93], v[48:49], v[40:41], v[92:93] op_sel:[1,1,0] op_sel_hi:[1,0,1] neg_lo:[1,0,0]
  v_cvt_pk_f16_f32 v101, v82, -v83
  v_cvt_pk_f16_f32 v94, v92, v93
  ds_write_b32 v113, v101 offset:13872
  ds_write_b32 v113, v94 offset:3264
  v_pk_mul_f32 v[70:71], v[62:63], v[54:55] op_sel:[0,0] op_sel_hi:[0,1]
  v_pk_mul_f32 v[84:85], v[82:83], v[80:81] op_sel:[0,0] op_sel_hi:[0,1]
  v_pk_fma_f32 v[70:71], v[62:63], v[54:55], v[70:71] op_sel:[1,1,0] op_sel_hi:[1,0,1] neg_lo:[1,0,0]
  v_pk_fma_f32 v[84:85], v[82:83], v[80:81], v[84:85] op_sel:[1,1,0] op_sel_hi:[1,0,1] neg_lo:[1,0,0]
  v_cvt_pk_f16_f32 v95, v70, v71
  v_cvt_pk_f16_f32 v96, v84, -v85
  ds_write_b32 v113, v95 offset:9792
  ds_write_b32 v113, v96 offset:14144
  v_pk_mul_f32 v[86:87], v[48:49], v[42:43] op_sel:[0,0] op_sel_hi:[0,1]
  v_pk_mul_f32 v[72:73], v[62:63], v[56:57] op_sel:[0,0] op_sel_hi:[0,1]
  v_pk_fma_f32 v[86:87], v[48:49], v[42:43], v[86:87] op_sel:[1,1,0] op_sel_hi:[1,0,1] neg_lo:[1,0,0]
  v_pk_fma_f32 v[72:73], v[62:63], v[56:57], v[72:73] op_sel:[1,1,0] op_sel_hi:[1,0,1] neg_lo:[1,0,0]
  v_cvt_pk_f16_f32 v97, v86, v87
  v_cvt_pk_f16_f32 v98, v72, v73
  ds_write_b32 v113, v97 offset:3536
  ds_write_b32 v113, v98 offset:10064
  v_pk_mul_f32 v[82:83], v[84:85], v[80:81] op_sel:[0,0] op_sel_hi:[0,1]
  v_pk_mul_f32 v[88:89], v[48:49], v[44:45] op_sel:[0,0] op_sel_hi:[0,1]
  v_pk_fma_f32 v[82:83], v[84:85], v[80:81], v[82:83] op_sel:[1,1,0] op_sel_hi:[1,0,1] neg_lo:[1,0,0]
  v_pk_fma_f32 v[88:89], v[48:49], v[44:45], v[88:89] op_sel:[1,1,0] op_sel_hi:[1,0,1] neg_lo:[1,0,0]
  v_cvt_pk_f16_f32 v99, v82, -v83
  v_cvt_pk_f16_f32 v100, v88, v89
  ds_write_b32 v113, v99 offset:14416
  ds_write_b32 v113, v100 offset:3808
  v_pk_mul_f32 v[74:75], v[62:63], v[58:59] op_sel:[0,0] op_sel_hi:[0,1]
  v_pk_mul_f32 v[84:85], v[82:83], v[80:81] op_sel:[0,0] op_sel_hi:[0,1]
  v_pk_fma_f32 v[74:75], v[62:63], v[58:59], v[74:75] op_sel:[1,1,0] op_sel_hi:[1,0,1] neg_lo:[1,0,0]
  v_pk_fma_f32 v[84:85], v[82:83], v[80:81], v[84:85] op_sel:[1,1,0] op_sel_hi:[1,0,1] neg_lo:[1,0,0]
  v_cvt_pk_f16_f32 v101, v74, v75
  v_cvt_pk_f16_f32 v94, v84, -v85
  ds_write_b32 v113, v101 offset:10336
  ds_write_b32 v113, v94 offset:14688
  v_pk_mul_f32 v[90:91], v[48:49], v[46:47] op_sel:[0,0] op_sel_hi:[0,1]
  v_pk_mul_f32 v[76:77], v[62:63], v[60:61] op_sel:[0,0] op_sel_hi:[0,1]
  v_pk_fma_f32 v[90:91], v[48:49], v[46:47], v[90:91] op_sel:[1,1,0] op_sel_hi:[1,0,1] neg_lo:[1,0,0]
  v_pk_fma_f32 v[76:77], v[62:63], v[60:61], v[76:77] op_sel:[1,1,0] op_sel_hi:[1,0,1] neg_lo:[1,0,0]
  v_cvt_pk_f16_f32 v95, v90, v91
  v_cvt_pk_f16_f32 v96, v76, v77
  ds_write_b32 v113, v95 offset:4080
  ds_write_b32 v113, v96 offset:10608
  v_pk_mul_f32 v[82:83], v[84:85], v[80:81] op_sel:[0,0] op_sel_hi:[0,1]
  v_pk_mul_f32 v[92:93], v[50:51], v[36:37] op_sel:[0,0] op_sel_hi:[0,1]
  v_pk_fma_f32 v[82:83], v[84:85], v[80:81], v[82:83] op_sel:[1,1,0] op_sel_hi:[1,0,1] neg_lo:[1,0,0]
  v_pk_fma_f32 v[92:93], v[50:51], v[36:37], v[92:93] op_sel:[1,1,0] op_sel_hi:[1,0,1] neg_lo:[1,0,0]
  v_cvt_pk_f16_f32 v97, v82, -v83
  v_cvt_pk_f16_f32 v98, v92, v93
  ds_write_b32 v113, v97 offset:14960
  ds_write_b32 v113, v98 offset:4624
  v_pk_mul_f32 v[78:79], v[62:63], v[62:63] op_sel:[0,0] op_sel_hi:[0,1]
  v_pk_mul_f32 v[84:85], v[82:83], v[80:81] op_sel:[0,0] op_sel_hi:[0,1]
  v_pk_fma_f32 v[78:79], v[62:63], v[62:63], v[78:79] op_sel:[1,1,0] op_sel_hi:[1,0,1] neg_lo:[1,0,0]
  v_pk_fma_f32 v[84:85], v[82:83], v[80:81], v[84:85] op_sel:[1,1,0] op_sel_hi:[1,0,1] neg_lo:[1,0,0]
  v_cvt_pk_f16_f32 v99, v78, v79
  v_cvt_pk_f16_f32 v100, v84, -v85
  ds_write_b32 v113, v99 offset:10880
  ds_write_b32 v113, v100 offset:15232
  s_cmp_lg_u32 s3, 0
  s_cbranch_scc1 LX_k0
  s_waitcnt vmcnt(1)
  s_branch LX_k1
LX_k0:
  s_waitcnt vmcnt(0)
LX_k1:
  s_mov_b64 exec, 1
  ds_add_rtn_u32 v128, v129, v132
  s_mov_b64 exec, -1
  s_cmp_lg_u32 s3, 0
  s_cbranch_scc1 LP_n1
  s_mov_b64 exec, 65535
  v_mov_b32 v134, 0
  buffer_atomic_add v134, v135, s[36:39], 0 offen offset:0 sc0 sc1
  s_mov_b64 exec, -1
LP_n1:
  ds_read_b128 v[148:151], v202 offset:11152
  ds_read_b128 v[136:139], v202 offset:0
  ds_read_b128 v[144:147], v203 offset:8704
  ds_read_b128 v[164:167], v202 offset:11216
  ds_read_b128 v[152:155], v202 offset:64
  ds_read_b128 v[160:163], v203 offset:8768
  ds_read_b128 v[180:183], v202 offset:11280
  ds_read_b128 v[168:171], v202 offset:128
  ds_read_b128 v[176:179], v203 offset:8832
  ds_read_b128 v[196:199], v202 offset:11344
  ds_read_b128 v[184:187], v202 offset:192
  ds_read_b128 v[192:195], v203 offset:8896
  v_pk_mul_f32 v[86:87], v[54:55], v[40:41] op_sel:[0,0] op_sel_hi:[0,1]
  v_pk_mul_f32 v[88:89], v[50:51], v[40:41] op_sel:[0,0] op_sel_hi:[0,1]
  v_pk_fma_f32 v[86:87], v[54:55], v[40:41], v[86:87] op_sel:[1,1,0] op_sel_hi:[1,0,1] neg_lo:[1,0,0]
  v_pk_fma_f32 v[88:89], v[50:51], v[40:41], v[88:89] op_sel:[1,1,0] op_sel_hi:[1,0,1] neg_lo:[1,0,0]
  v_cvt_pk_f16_f32 v101, v86, v87
  v_cvt_pk_f16_f32 v94, v88, v89
  ds_write_b32 v113, v101 offset:5168
  ds_write_b32 v113, v94 offset:5440
  v_pk_mul_f32 v[90:91], v[50:51], v[44:45] op_sel:[0,0] op_sel_hi:[0,1]
  s_waitcnt lgkmcnt(12)
  v_mfma_f32_16x16x32_f16 v[116:119], v[136:139], v[148:151], 0
  s_waitcnt lgkmcnt(11)
  v_mfma_f32_16x16x32_f16 v[124:127], v[144:147], v[148:151], 0
  v_readfirstlane_b32 s62, v128
  s_cmp_eq_u32 s62, 7
  s_cselect_b64 exec, 255, 0
  s_and_b32 s78, s2, 15
  s_lshl_b32 s78, s78, 10
  buffer_atomic_add v133, v131, s[36:39], s78 offen offset:12 sc1
  s_mov_b64 exec, -1
  v_pk_mul_f32 v[92:93], v[56:57], v[40:41] op_sel:[0,0] op_sel_hi:[0,1]
  v_pk_fma_f32 v[90:91], v[50:51], v[44:45], v[90:91] op_sel:[1,1,0] op_sel_hi:[1,0,1] neg_lo:[1,0,0]
  v_pk_fma_f32 v[92:93], v[56:57], v[40:41], v[92:93] op_sel:[1,1,0] op_sel_hi:[1,0,1] neg_lo:[1,0,0]
  v_cvt_pk_f16_f32 v95, v90, v91
  v_cvt_pk_f16_f32 v96, v92, v93
  ds_write_b32 v113, v95 offset:5712
  ds_write_b32 v113, v96 offset:6256
  v_pk_mul_f32 v[86:87], v[52:53], v[36:37] op_sel:[0,0] op_sel_hi:[0,1]
  v_pk_mul_f32 v[88:89], v[58:59], v[40:41] op_sel:[0,0] op_sel_hi:[0,1]
  s_waitcnt lgkmcnt(11)
  v_mfma_f32_16x16x32_f16 v[116:119], v[152:155], v[164:167], v[116:119]
  s_waitcnt lgkmcnt(10)
  v_mfma_f32_16x16x32_f16 v[124:127], v[160:163], v[164:167], v[124:127]
  v_pk_fma_f32 v[86:87], v[52:53], v[36:37], v[86:87] op_sel:[1,1,0] op_sel_hi:[1,0,1] neg_lo:[1,0,0]
  v_pk_fma_f32 v[88:89], v[58:59], v[40:41], v[88:89] op_sel:[1,1,0] op_sel_hi:[1,0,1] neg_lo:[1,0,0]
  v_cvt_pk_f16_f32 v97, v86, v87
  v_cvt_pk_f16_f32 v98, v88, v89
  ds_write_b32 v113, v97 offset:6800
  ds_write_b32 v113, v98 offset:7344
  v_pk_mul_f32 v[90:91], v[52:53], v[40:41] op_sel:[0,0] op_sel_hi:[0,1]
  v_pk_mul_f32 v[92:93], v[52:53], v[44:45] op_sel:[0,0] op_sel_hi:[0,1]
  v_pk_fma_f32 v[90:91], v[52:53], v[40:41], v[90:91] op_sel:[1,1,0] op_sel_hi:[1,0,1] neg_lo:[1,0,0]
  s_waitcnt lgkmcnt(10)
  v_mfma_f32_16x16x32_f16 v[116:119], v[168:171], v[180:183], v[116:119]
  s_waitcnt lgkmcnt(9)
  v_mfma_f32_16x16x32_f16 v[124:127], v[176:179], v[180:183], v[124:127]
  v_pk_fma_f32 v[92:93], v[52:53], v[44:45], v[92:93] op_sel:[1,1,0] op_sel_hi:[1,0,1] neg_lo:[1,0,0]
  v_cvt_pk_f16_f32 v99, v90, v91
  v_cvt_pk_f16_f32 v100, v92, v93
  ds_write_b32 v113, v99 offset:7616
  ds_write_b32 v113, v100 offset:7888
  v_pk_mul_f32 v[86:87], v[60:61], v[40:41] op_sel:[0,0] op_sel_hi:[0,1]
  v_pk_fma_f32 v[86:87], v[60:61], v[40:41], v[86:87] op_sel:[1,1,0] op_sel_hi:[1,0,1] neg_lo:[1,0,0]
  v_cvt_pk_f16_f32 v101, v86, v87
  ds_write_b32 v113, v101 offset:8432
  ds_read_b128 v[140:143], v202 offset:4352
  ds_read_b128 v[156:159], v202 offset:4416
  ds_read_b128 v[172:175], v202 offset:4480
  ds_read_b128 v[188:191], v202 offset:4544
  s_waitcnt lgkmcnt(14)
  v_mfma_f32_16x16x32_f16 v[116:119], v[184:187], v[196:199], v[116:119]
  s_waitcnt lgkmcnt(13)
  v_mfma_f32_16x16x32_f16 v[124:127], v[192:195], v[196:199], v[124:127]
  s_waitcnt lgkmcnt(3)
  v_mfma_f32_16x16x32_f16 v[120:123], v[140:143], v[148:151], 0
  s_waitcnt lgkmcnt(2)
  v_mfma_f32_16x16x32_f16 v[120:123], v[156:159], v[164:167], v[120:123]
  s_waitcnt lgkmcnt(1)
  v_mfma_f32_16x16x32_f16 v[120:123], v[172:175], v[180:183], v[120:123]
  s_waitcnt lgkmcnt(0)
  v_mfma_f32_16x16x32_f16 v[120:123], v[188:191], v[196:199], v[120:123]
  ds_write_b128 v234, v[116:119] offset:0
  ds_write_b128 v234, v[124:127] offset:2048
  s_nop 5
  ds_write_b128 v234, v[120:123] offset:1024
  s_cmp_lg_u32 s3, 0
  s_cbranch_scc1 LP_doneA
  s_mov_b32 s79, 0
LP_loopA:
  s_waitcnt vmcnt(0)
  v_cmp_ne_u32 vcc, 16, v134
  s_and_b32 s78, vcc_lo, 65535
  s_cbranch_scc0 LP_doneA
  s_mov_b64 exec, 65535
  v_mov_b32 v134, 0
  buffer_atomic_add v134, v135, s[36:39], 0 offen offset:0 sc0 sc1
  s_mov_b64 exec, -1
  s_add_u32 s79, s79, 1
  s_cmp_lt_u32 s79, 100000
  s_cbranch_scc1 LP_loopA
  s_waitcnt vmcnt(0)
LP_doneA:
  s_waitcnt vmcnt(0) lgkmcnt(0)
  s_barrier
  buffer_load_dwordx4 v[72:75], v211, s[56:59], s90 offen offset:0 sc1
  buffer_load_dwordx4 v[76:79], v211, s[56:59], s90 offen offset:1024 sc1
  v_mov_b32 v249, 0
  ds_write_b32 v249, v249
  ds_read_b128 v[36:39], v235 offset:0
  ds_read_b128 v[40:43], v235 offset:1024
  ds_read_b128 v[44:47], v235 offset:2048
  v_mov_b32 v68, 0
  v_mov_b32 v69, 0
  ds_write_b32 v207, v68 offset:4096
  ds_write_b64 v209, v[68:69]
  s_waitcnt lgkmcnt(2)
  v_add_f32 v116, v116, v36
  v_add_f32 v117, v117, v37
  v_add_f32 v118, v118, v38
  v_add_f32 v119, v119, v39
  v_add_f32 v120, v120, v40
  v_add_f32 v121, v121, v41
  v_add_f32 v122, v122, v42
  v_add_f32 v123, v123, v43
  v_add_f32 v124, v124, v44
  v_add_f32 v125, v125, v45
  v_add_f32 v126, v126, v46
  v_cvt_pk_f16_f32 v58, v126, v126
  v_cvt_pk_f16_f32 v60, v123, v123
  v_cvt_pk_f16_f32 v62, v122, v122
  s_cmp_lg_u32 s85, 0
  s_cbranch_scc1 L_exp0
  s_mov_b32 s64, 0xaaaaaaaa
  s_mov_b32 s65, 0xaaaaaaaa
  v_mov_b32_dpp v56, v124 row_shr:1 row_mask:0xf bank_mask:0xf bound_ctrl:0
  v_cvt_pk_f16_f32 v48, v124, v124
  v_cndmask_b32 v56, v124, v56, s[64:65]
  v_mov_b32 v49, v48
  v_mov_b32 v50, v48
  v_cvt_pk_f16_f32 v51, v124, v56
  ds_write2_b64 v204, v[48:49], v[50:51] offset0:32 offset1:33
  v_mov_b32_dpp v57, v125 row_shr:1 row_mask:0xf bank_mask:0xf bound_ctrl:0
  v_cvt_pk_f16_f32 v52, v125, v125
  v_cndmask_b32 v57, v125, v57, s[64:65]
  v_mov_b32 v53, v52
  v_mov_b32 v54, v52
  v_cvt_pk_f16_f32 v55, v125, v57
  ds_write2_b64 v204, v[52:53], v[54:55] offset0:0 offset1:1
  v_mov_b32 v59, v58
  s_mov_b64 exec, 1
  ds_write_b64 v208, v[58:59]
  s_mov_b64 exec, -1
  v_cvt_pk_f16_f32 v61, v123, v122
  ds_write2_b32 v205, v60, v61 offset0:0 offset1:1
  ds_write2_b32 v205, v62, v62 offset0:2 offset1:3
  v_cvt_pk_f16_f32 v63, v121, v121
  v_cvt_pk_f16_f32 v64, v120, v120
  ds_write_b16 v206, v63
  ds_write_b32 v206, v64 offset:2
  ds_write_b16 v206, v64 offset:6
  v_cvt_pk_f16_f32 v66, v119, v118
  v_cvt_pk_f16_f32 v67, v117, v116
  ds_write_b64 v206, v[66:67] offset:510
  s_branch L_exp1
L_exp0:
  v_cvt_pk_f16_f32 v48, v124, v124
  ds_write2_b32 v204, v48, v48 offset0:65 offset1:66
  ds_write2_b32 v204, v48, v48 offset0:67 offset1:68
  v_cvt_pk_f16_f32 v49, v125, v125
  ds_write2_b32 v204, v49, v49 offset0:1 offset1:2
  ds_write2_b32 v204, v49, v49 offset0:3 offset1:4
  s_mov_b32 exec_lo, 0x55555555
  s_mov_b32 exec_hi, 0x55555555
  ds_write_b16 v204, v48 offset:276
  ds_write_b16 v204, v49 offset:20
  s_mov_b64 exec, 1
  ds_write_b32 v208, v58
  ds_write_b16 v208, v58 offset:4
  ds_write_b16 v208, v68 offset:4094
  s_mov_b64 exec, -1
  v_mov_b32 v63, v62
  ds_write_b16 v205, v60 offset:2
  ds_write_b32 v205, v60 offset:4
  ds_write_b64 v205, v[62:63] offset:8
  ds_write_b16 v205, v62 offset:16
  v_cvt_pk_f16_f32 v64, v121, v120
  v_cvt_pk_f16_f32 v65, v120, v120
  ds_write_b64 v206, v[64:65]
  v_cvt_pk_f16_f32 v66, v119, v116
  v_cvt_pk_f16_f32 v67, v118, v117
  ds_write_b16 v206, v66 offset:510
  ds_write_b32 v206, v67 offset:512
  ds_write_b16_d16_hi v206, v66 offset:516
L_exp1:
  s_waitcnt vmcnt(1)
  ds_write_b128 v239, v[72:75] offset:0
  s_waitcnt vmcnt(0)
  ds_write_b128 v239, v[76:79] offset:256
  s_waitcnt lgkmcnt(0)
  s_barrier
  s_cmp_eq_u32 s3, 0
  s_cselect_b64 exec, 65535, 0
  v_mov_b32 v244, 0
  buffer_atomic_add v244, v246, s[36:39], 0 offen offset:12 sc0 sc1
  s_mov_b64 exec, -1
  s_cmp_lg_u32 s85, 0
  s_cbranch_scc1 L_cvB
  s_setprio 3
  ds_read_b64 v[18:19], v233 offset:0
  ds_read_b64 v[20:21], v233 offset:1536
  ds_read_b64 v[22:23], v233 offset:2048
  ds_read_b64 v[24:25], v233 offset:3584
  ds_read2_b32 v[68:69], v229 offset0:224 offset1:225
  ds_read2_b32 v[70:71], v229 offset0:226 offset1:227
  ds_read_b128 v[36:39], v228 offset:384
  ds_read2_b32 v[72:73], v229 offset0:96 offset1:97
  ds_read2_b32 v[74:75], v229 offset0:98 offset1:99
  ds_read_b128 v[40:43], v228 offset:896
  ds_read2_b32 v[76:77], v230 offset0:224 offset1:225
  ds_read2_b32 v[78:79], v230 offset0:226 offset1:227
  ds_read_b128 v[44:47], v228 offset:1408
  ds_read2_b32 v[80:81], v230 offset0:96 offset1:97
  s_waitcnt lgkmcnt(7)
  v_mfma_f32_16x16x32_f16 v[164:167], v[68:71], v[36:39], 0
  ds_read2_b32 v[82:83], v230 offset0:98 offset1:99
  ds_read_b128 v[48:51], v228 offset:1920
  s_waitcnt lgkmcnt(6)
  v_mfma_f32_16x16x32_f16 v[168:171], v[68:71], v[40:43], 0
  ds_read2_b32 v[84:85], v231 offset0:224 offset1:225
  ds_read2_b32 v[86:87], v231 offset0:226 offset1:227
  v_mfma_f32_16x16x32_f16 v[168:171], v[72:75], v[36:39], v[168:171]
  ds_read_b128 v[52:55], v228 offset:2432
  ds_read2_b32 v[88:89], v231 offset0:96 offset1:97
  s_waitcnt lgkmcnt(7)
  v_mfma_f32_16x16x32_f16 v[172:175], v[68:71], v[44:47], 0
  ds_read2_b32 v[90:91], v231 offset0:98 offset1:99
  ds_read_b128 v[56:59], v228 offset:2944
  v_mfma_f32_16x16x32_f16 v[172:175], v[72:75], v[40:43], v[172:175]
  ds_read2_b32 v[92:93], v232 offset0:224 offset1:225
  ds_read2_b32 v[94:95], v232 offset0:226 offset1:227
  v_mfma_f32_16x16x32_f16 v[172:175], v[76:79], v[36:39], v[172:175]
  ds_read_b128 v[60:63], v228 offset:3456
  ds_read2_b32 v[96:97], v232 offset0:96 offset1:97
  s_waitcnt lgkmcnt(8)
  v_mfma_f32_16x16x32_f16 v[176:179], v[68:71], v[48:51], 0
  ds_read2_b32 v[98:99], v232 offset0:98 offset1:99
  ds_read_b128 v[64:67], v228 offset:3968
  v_mfma_f32_16x16x32_f16 v[176:179], v[72:75], v[44:47], v[176:179]
  ds_read2_b32 v[132:133], v229 offset0:192 offset1:193
  ds_read2_b32 v[134:135], v229 offset0:194 offset1:195
  v_mfma_f32_16x16x32_f16 v[176:179], v[76:79], v[40:43], v[176:179]
  ds_read_b128 v[100:103], v228 offset:256
  ds_read2_b32 v[136:137], v229 offset0:64 offset1:65
  v_mfma_f32_16x16x32_f16 v[176:179], v[80:83], v[36:39], v[176:179]
  s_waitcnt lgkmcnt(8)
  ds_read2_b32 v[138:139], v229 offset0:66 offset1:67
  ds_read_b128 v[104:107], v228 offset:768
  v_mfma_f32_16x16x32_f16 v[180:183], v[68:71], v[52:55], 0
  ds_read2_b32 v[140:141], v230 offset0:192 offset1:193
  ds_read2_b32 v[142:143], v230 offset0:194 offset1:195
  v_mfma_f32_16x16x32_f16 v[180:183], v[72:75], v[48:51], v[180:183]
  ds_read_b128 v[108:111], v228 offset:1280
  ds_read2_b32 v[144:145], v230 offset0:64 offset1:65
  v_mfma_f32_16x16x32_f16 v[180:183], v[76:79], v[44:47], v[180:183]
  s_waitcnt lgkmcnt(8)
  ds_read2_b32 v[146:147], v230 offset0:66 offset1:67
  v_mfma_f32_16x16x32_f16 v[180:183], v[80:83], v[40:43], v[180:183]
  ds_read_b128 v[112:115], v228 offset:1792
  v_mfma_f32_16x16x32_f16 v[180:183], v[84:87], v[36:39], v[180:183]
  ds_read2_b32 v[148:149], v231 offset0:192 offset1:193
  v_lshlrev_b32 v28, 16, v26
  v_mfma_f32_16x16x32_f16 v[184:187], v[68:71], v[56:59], 0
  ds_read2_b32 v[150:151], v231 offset0:194 offset1:195
  v_cvt_f32_f16 v212, v18
  v_mfma_f32_16x16x32_f16 v[184:187], v[72:75], v[52:55], v[184:187]
  ds_read_b128 v[116:119], v228 offset:2304
  s_cmp_lg_u32 s3, 0
  s_cbranch_scc1 LP_doneX
  s_mov_b32 s79, 0
LP_loopX:
  s_waitcnt vmcnt(0)
  v_cmp_gt_u32 vcc, 4096, v244
  s_and_b32 s78, vcc_lo, 65535
  s_cbranch_scc0 LP_doneX
  s_mov_b64 exec, 65535
  v_mov_b32 v244, 0
  buffer_atomic_add v244, v246, s[36:39], 0 offen offset:12 sc0 sc1
  s_mov_b64 exec, -1
  s_add_u32 s79, s79, 1
  s_cmp_lt_u32 s79, 100000
  s_cbranch_scc1 LP_loopX
  s_waitcnt vmcnt(0)
LP_doneX:
  s_cmp_eq_u32 s3, 0
  s_cselect_b64 exec, 1, 0
  ds_write_b32 v249, v248
  s_mov_b64 exec, -1
  v_cvt_f32_f16_sdwa v213, v18 dst_sel:DWORD dst_unused:UNUSED_PAD src0_sel:WORD_1
  v_mfma_f32_16x16x32_f16 v[184:187], v[76:79], v[48:51], v[184:187]
  s_waitcnt lgkmcnt(5)
  ds_read2_b32 v[152:153], v231 offset0:64 offset1:65
  ds_read_b32 v250, v249
  v_cvt_f32_f16 v214, v19
  v_mfma_f32_16x16x32_f16 v[184:187], v[80:83], v[44:47], v[184:187]
  ds_read2_b32 v[154:155], v231 offset0:66 offset1:67
  v_cvt_f32_f16_sdwa v215, v19 dst_sel:DWORD dst_unused:UNUSED_PAD src0_sel:WORD_1
  v_mfma_f32_16x16x32_f16 v[184:187], v[84:87], v[40:43], v[184:187]
  ds_read_b128 v[120:123], v228 offset:2816
  v_cvt_f32_f16 v216, v20
  v_mfma_f32_16x16x32_f16 v[184:187], v[88:91], v[36:39], v[184:187]
  ds_read2_b32 v[156:157], v232 offset0:192 offset1:193
  v_cvt_f32_f16_sdwa v217, v20 dst_sel:DWORD dst_unused:UNUSED_PAD src0_sel:WORD_1
  v_mfma_f32_16x16x32_f16 v[188:191], v[68:71], v[60:63], 0
  ds_read2_b32 v[158:159], v232 offset0:194 offset1:195
  v_cvt_f32_f16 v218, v21
  v_mfma_f32_16x16x32_f16 v[188:191], v[72:75], v[56:59], v[188:191]
  ds_read_b128 v[124:127], v228 offset:3328
  s_waitcnt lgkmcnt(5)
  s_mov_b32 s79, 0
LC_xsA:
  v_readfirstlane_b32 s78, v250
  s_lshr_b32 s77, s79, 22
  s_or_b32 s78, s78, s77
  s_cbranch_scc1 LC_xoA
  s_waitcnt lgkmcnt(0)
  ds_read_b32 v250, v249
  s_add_u32 s79, s79, 1
  s_waitcnt lgkmcnt(0)
  s_branch LC_xsA
LC_xoA:
  s_add_u32 s60, s91, 0
  buffer_load_dwordx2 v[10:11], v210, s[56:59], s60 offen offset:0 sc1
  s_add_u32 s60, s91, 4096
  buffer_load_dwordx2 v[12:13], v210, s[56:59], s60 offen offset:2048 sc1
  s_add_u32 s60, s91, 8192
  buffer_load_dwordx2 v[14:15], v210, s[56:59], s60 offen offset:0 sc1
  s_add_u32 s60, s91, 12288
  buffer_load_dwordx2 v[16:17], v210, s[56:59], s60 offen offset:2048 sc1
  v_cvt_f32_f16_sdwa v219, v21 dst_sel:DWORD dst_unused:UNUSED_PAD src0_sel:WORD_1
  v_mfma_f32_16x16x32_f16 v[188:191], v[76:79], v[52:55], v[188:191]
  ds_read2_b32 v[160:161], v232 offset0:64 offset1:65
  v_cvt_f32_f16 v220, v22
  v_mfma_f32_16x16x32_f16 v[188:191], v[80:83], v[48:51], v[188:191]
  ds_read2_b32 v[162:163], v232 offset0:66 offset1:67
  v_cvt_f32_f16_sdwa v221, v22 dst_sel:DWORD dst_unused:UNUSED_PAD src0_sel:WORD_1
  v_mfma_f32_16x16x32_f16 v[188:191], v[84:87], v[44:47], v[188:191]
  ds_read_b128 v[128:131], v228 offset:3840
  v_cvt_f32_f16 v222, v23
  v_mfma_f32_16x16x32_f16 v[188:191], v[88:91], v[40:43], v[188:191]
  v_cvt_f32_f16_sdwa v223, v23 dst_sel:DWORD dst_unused:UNUSED_PAD src0_sel:WORD_1
  v_mfma_f32_16x16x32_f16 v[188:191], v[92:95], v[36:39], v[188:191]
  v_cvt_f32_f16 v224, v24
  v_mfma_f32_16x16x32_f16 v[192:195], v[68:71], v[64:67], 0
  ds_read2_b32 v[68:69], v229 offset0:160 offset1:161
  v_cvt_f32_f16_sdwa v225, v24 dst_sel:DWORD dst_unused:UNUSED_PAD src0_sel:WORD_1
  v_mfma_f32_16x16x32_f16 v[192:195], v[72:75], v[60:63], v[192:195]
  ds_read2_b32 v[70:71], v229 offset0:162 offset1:163
  v_cvt_f32_f16 v226, v25
  v_mfma_f32_16x16x32_f16 v[192:195], v[76:79], v[56:59], v[192:195]
  v_cvt_f32_f16_sdwa v227, v25 dst_sel:DWORD dst_unused:UNUSED_PAD src0_sel:WORD_1
  v_mfma_f32_16x16x32_f16 v[192:195], v[80:83], v[52:55], v[192:195]
  v_mul_f32 v212, v212, v28
  v_mfma_f32_16x16x32_f16 v[192:195], v[84:87], v[48:51], v[192:195]
  v_mul_f32 v213, v213, v28
  v_mfma_f32_16x16x32_f16 v[192:195], v[88:91], v[44:47], v[192:195]
  v_mul_f32 v214, v214, v28
  v_mfma_f32_16x16x32_f16 v[192:195], v[92:95], v[40:43], v[192:195]
  v_mul_f32 v215, v215, v28
  v_mfma_f32_16x16x32_f16 v[192:195], v[96:99], v[36:39], v[192:195]
  ds_read_b128 v[36:39], v228 offset:128
  v_mul_f32 v216, v216, v28
  v_mfma_f32_16x16x32_f16 v[164:167], v[132:135], v[100:103], v[164:167]
  ds_read2_b32 v[72:73], v229 offset0:32 offset1:33
  s_setprio 2
  v_mul_f32 v217, v217, v28
  v_mfma_f32_16x16x32_f16 v[168:171], v[132:135], v[104:107], v[168:171]
  ds_read2_b32 v[74:75], v229 offset0:34 offset1:35
  v_mul_f32 v218, v218, v28
  v_mfma_f32_16x16x32_f16 v[168:171], v[136:139], v[100:103], v[168:171]
  ds_read_b128 v[40:43], v228 offset:640
  v_mul_f32 v219, v219, v28
  v_mfma_f32_16x16x32_f16 v[172:175], v[132:135], v[108:111], v[172:175]
  s_waitcnt lgkmcnt(4)
  ds_read2_b32 v[76:77], v230 offset0:160 offset1:161
  v_mul_f32 v220, v220, v28
  v_mfma_f32_16x16x32_f16 v[172:175], v[136:139], v[104:107], v[172:175]
  ds_read2_b32 v[78:79], v230 offset0:162 offset1:163
  v_mul_f32 v221, v221, v28
  v_mfma_f32_16x16x32_f16 v[172:175], v[140:143], v[100:103], v[172:175]
  ds_read_b128 v[44:47], v228 offset:1152
  v_mul_f32 v222, v222, v28
  v_mfma_f32_16x16x32_f16 v[176:179], v[132:135], v[112:115], v[176:179]
  ds_read2_b32 v[88:89], v231 offset0:32 offset1:33
  v_mul_f32 v223, v223, v28
  v_mfma_f32_16x16x32_f16 v[176:179], v[136:139], v[108:111], v[176:179]
  ds_read2_b32 v[90:91], v231 offset0:34 offset1:35
  v_mul_f32 v224, v224, v28
  v_mfma_f32_16x16x32_f16 v[176:179], v[140:143], v[104:107], v[176:179]
  ds_read_b128 v[56:59], v228 offset:2688
  v_mul_f32 v225, v225, v28
  v_mfma_f32_16x16x32_f16 v[176:179], v[144:147], v[100:103], v[176:179]
  ds_read2_b32 v[84:85], v231 offset0:160 offset1:161
  v_mul_f32 v226, v226, v28
  v_mfma_f32_16x16x32_f16 v[180:183], v[132:135], v[116:119], v[180:183]
  ds_read2_b32 v[86:87], v231 offset0:162 offset1:163
  v_mul_f32 v227, v227, v28
  v_mfma_f32_16x16x32_f16 v[180:183], v[136:139], v[112:115], v[180:183]
  ds_read_b128 v[52:55], v228 offset:2176
  v_cvt_pk_bf16_f32 v212, 0, v212
  v_mfma_f32_16x16x32_f16 v[180:183], v[140:143], v[108:111], v[180:183]
  ds_read2_b32 v[80:81], v230 offset0:32 offset1:33
  v_cvt_pk_bf16_f32 v213, 0, v213
  v_mfma_f32_16x16x32_f16 v[180:183], v[144:147], v[104:107], v[180:183]
  s_waitcnt lgkmcnt(4)
  ds_read2_b32 v[82:83], v230 offset0:34 offset1:35
  v_cvt_pk_bf16_f32 v214, 0, v214
  v_mfma_f32_16x16x32_f16 v[180:183], v[148:151], v[100:103], v[180:183]
  ds_read_b128 v[48:51], v228 offset:1664
  v_cvt_pk_bf16_f32 v215, 0, v215
  v_mfma_f32_16x16x32_f16 v[184:187], v[132:135], v[120:123], v[184:187]
  ds_read2_b32 v[92:93], v232 offset0:160 offset1:161
  v_cvt_pk_bf16_f32 v216, 0, v216
  v_mfma_f32_16x16x32_f16 v[184:187], v[136:139], v[116:119], v[184:187]
  ds_read2_b32 v[94:95], v232 offset0:162 offset1:163
  v_cvt_pk_bf16_f32 v217, 0, v217
  v_mfma_f32_16x16x32_f16 v[184:187], v[140:143], v[112:115], v[184:187]
  ds_read_b128 v[60:63], v228 offset:3200
  v_cvt_pk_bf16_f32 v218, 0, v218
  v_mfma_f32_16x16x32_f16 v[184:187], v[144:147], v[108:111], v[184:187]
  v_cvt_pk_bf16_f32 v219, 0, v219
  v_mfma_f32_16x16x32_f16 v[184:187], v[148:151], v[104:107], v[184:187]
  v_cvt_pk_bf16_f32 v220, 0, v220
  v_mfma_f32_16x16x32_f16 v[184:187], v[152:155], v[100:103], v[184:187]
  v_cvt_pk_bf16_f32 v221, 0, v221
  v_mfma_f32_16x16x32_f16 v[188:191], v[132:135], v[124:127], v[188:191]
  v_cvt_pk_bf16_f32 v222, 0, v222
  v_mfma_f32_16x16x32_f16 v[188:191], v[136:139], v[120:123], v[188:191]
  v_cvt_pk_bf16_f32 v223, 0, v223
  v_mfma_f32_16x16x32_f16 v[188:191], v[140:143], v[116:119], v[188:191]
  v_cvt_pk_bf16_f32 v224, 0, v224
  v_mfma_f32_16x16x32_f16 v[188:191], v[144:147], v[112:115], v[188:191]
  v_cvt_pk_bf16_f32 v225, 0, v225
  v_mfma_f32_16x16x32_f16 v[188:191], v[148:151], v[108:111], v[188:191]
  v_cvt_pk_bf16_f32 v226, 0, v226
  v_mfma_f32_16x16x32_f16 v[188:191], v[152:155], v[104:107], v[188:191]
  v_cvt_pk_bf16_f32 v227, 0, v227
  v_mfma_f32_16x16x32_f16 v[188:191], v[156:159], v[100:103], v[188:191]
  v_mfma_f32_16x16x32_f16 v[192:195], v[132:135], v[128:131], v[192:195]
  ds_read2_b32 v[132:133], v229 offset0:128 offset1:129
  ds_read2_b32 v[134:135], v229 offset0:130 offset1:131
  v_mfma_f32_16x16x32_f16 v[192:195], v[160:163], v[100:103], v[192:195]
  ds_read_b128 v[100:103], v228 offset:0
  v_mfma_f32_16x16x32_f16 v[192:195], v[136:139], v[124:127], v[192:195]
  ds_read2_b32 v[136:137], v229 offset0:0 offset1:1
  ds_read2_b32 v[138:139], v229 offset0:2 offset1:3
  v_mfma_f32_16x16x32_f16 v[192:195], v[156:159], v[104:107], v[192:195]
  s_waitcnt lgkmcnt(5)
  ds_read_b128 v[104:107], v228 offset:512
  v_mfma_f32_16x16x32_f16 v[192:195], v[140:143], v[120:123], v[192:195]
  ds_read2_b32 v[140:141], v230 offset0:128 offset1:129
  ds_read2_b32 v[142:143], v230 offset0:130 offset1:131
  v_mfma_f32_16x16x32_f16 v[192:195], v[152:155], v[108:111], v[192:195]
  ds_read_b128 v[108:111], v228 offset:1024
  ds_read2_b32 v[152:153], v231 offset0:0 offset1:1
  v_mfma_f32_16x16x32_f16 v[192:195], v[144:147], v[116:119], v[192:195]
  ds_read2_b32 v[154:155], v231 offset0:2 offset1:3
  ds_read_b128 v[120:123], v228 offset:2560
  v_mfma_f32_16x16x32_f16 v[192:195], v[148:151], v[112:115], v[192:195]
  ds_read2_b32 v[148:149], v231 offset0:128 offset1:129
  ds_read2_b32 v[150:151], v231 offset0:130 offset1:131
  v_mfma_f32_16x16x32_f16 v[168:171], v[68:71], v[40:43], v[168:171]
  s_waitcnt lgkmcnt(8)
  ds_read_b128 v[116:119], v228 offset:2048
  ds_read2_b32 v[144:145], v230 offset0:0 offset1:1
  v_mfma_f32_16x16x32_f16 v[168:171], v[72:75], v[36:39], v[168:171]
  ds_read2_b32 v[146:147], v230 offset0:2 offset1:3
  ds_read_b128 v[112:115], v228 offset:1536
  v_mfma_f32_16x16x32_f16 v[172:175], v[68:71], v[44:47], v[172:175]
  ds_read2_b32 v[156:157], v232 offset0:128 offset1:129
  ds_read2_b32 v[158:159], v232 offset0:130 offset1:131
  v_mfma_f32_16x16x32_f16 v[172:175], v[72:75], v[40:43], v[172:175]
  s_waitcnt lgkmcnt(8)
  ds_read_b128 v[124:127], v228 offset:3072
  ds_read2_b32 v[96:97], v232 offset0:32 offset1:33
  v_mfma_f32_16x16x32_f16 v[172:175], v[76:79], v[36:39], v[172:175]
  ds_read2_b32 v[98:99], v232 offset0:34 offset1:35
  ds_read_b128 v[64:67], v228 offset:3712
  v_mfma_f32_16x16x32_f16 v[184:187], v[68:71], v[56:59], v[184:187]
  ds_read2_b32 v[160:161], v232 offset0:0 offset1:1
  ds_read2_b32 v[162:163], v232 offset0:2 offset1:3
  v_mfma_f32_16x16x32_f16 v[184:187], v[72:75], v[52:55], v[184:187]
  s_waitcnt lgkmcnt(8)
  ds_read_b128 v[128:131], v228 offset:3584
  v_mfma_f32_16x16x32_f16 v[184:187], v[76:79], v[48:51], v[184:187]
  v_mfma_f32_16x16x32_f16 v[184:187], v[80:83], v[44:47], v[184:187]
  s_setprio 1
  v_mfma_f32_16x16x32_f16 v[184:187], v[84:87], v[40:43], v[184:187]
  v_mfma_f32_16x16x32_f16 v[184:187], v[88:91], v[36:39], v[184:187]
  v_mfma_f32_16x16x32_f16 v[188:191], v[68:71], v[60:63], v[188:191]
  v_mfma_f32_16x16x32_f16 v[188:191], v[72:75], v[56:59], v[188:191]
  v_mfma_f32_16x16x32_f16 v[188:191], v[76:79], v[52:55], v[188:191]
  v_mfma_f32_16x16x32_f16 v[188:191], v[80:83], v[48:51], v[188:191]
  v_mfma_f32_16x16x32_f16 v[188:191], v[84:87], v[44:47], v[188:191]
  v_mfma_f32_16x16x32_f16 v[188:191], v[88:91], v[40:43], v[188:191]
  v_mfma_f32_16x16x32_f16 v[188:191], v[92:95], v[36:39], v[188:191]
  v_mfma_f32_16x16x32_f16 v[168:171], v[132:135], v[104:107], v[168:171]
  v_mfma_f32_16x16x32_f16 v[168:171], v[136:139], v[100:103], v[168:171]
  v_mfma_f32_16x16x32_f16 v[172:175], v[132:135], v[108:111], v[172:175]
  v_mfma_f32_16x16x32_f16 v[172:175], v[136:139], v[104:107], v[172:175]
  v_mfma_f32_16x16x32_f16 v[172:175], v[140:143], v[100:103], v[172:175]
  s_nop 4
  v_mul_f32 v168, v168, v240
  v_mfma_f32_16x16x32_f16 v[184:187], v[132:135], v[120:123], v[184:187]
  v_mul_f32 v169, v169, v240
  v_mfma_f32_16x16x32_f16 v[184:187], v[136:139], v[116:119], v[184:187]
  s_waitcnt vmcnt(0)
  v_mul_f32 v170, v170, v240
  v_mul_f32 v171, v171, v240
  v_mfma_f32_16x16x32_f16 v[184:187], v[140:143], v[112:115], v[184:187]
  ds_write_b128 v234, v[168:171] offset:0
  v_lshlrev_b32 v196, 16, v10
  v_mfma_f32_16x16x32_f16 v[184:187], v[144:147], v[108:111], v[184:187]
  v_and_b32 v197, s82, v10
  v_lshlrev_b32 v198, 16, v11
  v_mfma_f32_16x16x32_f16 v[184:187], v[148:151], v[104:107], v[184:187]
  v_and_b32 v199, s82, v11
  v_lshlrev_b32 v200, 16, v12
  v_mfma_f32_16x16x32_f16 v[184:187], v[152:155], v[100:103], v[184:187]
  v_and_b32 v201, s82, v12
  v_lshlrev_b32 v202, 16, v13
  s_waitcnt lgkmcnt(1)
  v_mfma_f32_16x16x32_f16 v[188:191], v[132:135], v[124:127], v[188:191]
  v_and_b32 v203, s82, v13
  v_lshlrev_b32 v204, 16, v14
  v_mfma_f32_16x16x32_f16 v[188:191], v[136:139], v[120:123], v[188:191]
  v_and_b32 v205, s82, v14
  v_lshlrev_b32 v206, 16, v15
  v_mfma_f32_16x16x32_f16 v[188:191], v[140:143], v[116:119], v[188:191]
  v_and_b32 v207, s82, v15
  v_lshlrev_b32 v208, 16, v16
  v_mfma_f32_16x16x32_f16 v[188:191], v[144:147], v[112:115], v[188:191]
  s_setprio 0
  v_and_b32 v209, s82, v16
  v_lshlrev_b32 v210, 16, v17
  v_mfma_f32_16x16x32_f16 v[188:191], v[148:151], v[108:111], v[188:191]
  v_and_b32 v211, s82, v17
  v_mul_f32 v172, v172, v240
  v_mfma_f32_16x16x32_f16 v[188:191], v[152:155], v[104:107], v[188:191]
  v_mul_f32 v173, v173, v240
  v_mul_f32 v174, v174, v240
  v_mfma_f32_16x16x32_f16 v[188:191], v[156:159], v[100:103], v[188:191]
  v_mul_f32 v175, v175, v240
  ds_write_b128 v234, v[172:175] offset:1024
  v_mfma_f32_16x16x32_f16 v[164:167], v[68:71], v[36:39], v[164:167]
  v_mul_f32 v184, v184, v240
  v_mul_f32 v185, v185, v240
  v_mfma_f32_16x16x32_f16 v[164:167], v[132:135], v[100:103], v[164:167]
  v_mul_f32 v186, v186, v240
  v_mul_f32 v187, v187, v240
  v_mfma_f32_16x16x32_f16 v[176:179], v[68:71], v[48:51], v[176:179]
  ds_write_b128 v234, v[184:187] offset:2048
  v_mul_f32 v188, v188, v240
  v_mfma_f32_16x16x32_f16 v[176:179], v[72:75], v[44:47], v[176:179]
  v_mul_f32 v189, v189, v240
  v_mul_f32 v190, v190, v240
  v_mfma_f32_16x16x32_f16 v[176:179], v[76:79], v[40:43], v[176:179]
  v_mul_f32 v191, v191, v240
  ds_write_b128 v234, v[188:191] offset:3072
  v_mfma_f32_16x16x32_f16 v[176:179], v[80:83], v[36:39], v[176:179]
  s_waitcnt lgkmcnt(0)
  s_barrier
  s_setprio 3
  ds_read_b128 v[10:13], v235 offset:0
  ds_read_b128 v[14:17], v235 offset:1024
  ds_read_b128 v[18:21], v235 offset:2048
  v_mfma_f32_16x16x32_f16 v[176:179], v[132:135], v[112:115], v[176:179]
  ds_read_b128 v[22:25], v235 offset:3072
  v_mfma_f32_16x16x32_f16 v[176:179], v[136:139], v[108:111], v[176:179]
  v_mfma_f32_16x16x32_f16 v[176:179], v[140:143], v[104:107], v[176:179]
  v_mfma_f32_16x16x32_f16 v[176:179], v[144:147], v[100:103], v[176:179]
  s_waitcnt lgkmcnt(3)
  v_fma_f32 v10, v164, v240, v10
  v_fma_f32 v11, v165, v240, v11
  v_fma_f32 v12, v166, v240, v12
  v_mfma_f32_16x16x32_f16 v[180:183], v[68:71], v[52:55], v[180:183]
  v_fma_f32 v13, v167, v240, v13
  v_cvt_pk_bf16_f32 v10, 0, v10
  v_cvt_pk_bf16_f32 v11, 0, v11
  v_mfma_f32_16x16x32_f16 v[180:183], v[72:75], v[48:51], v[180:183]
  v_cvt_pk_bf16_f32 v12, 0, v12
  v_cvt_pk_bf16_f32 v13, 0, v13
  v_add_f32 v10, v10, v212
  v_mfma_f32_16x16x32_f16 v[180:183], v[76:79], v[44:47], v[180:183]
  v_add_f32 v11, v11, v213
  v_add_f32 v12, v12, v214
  v_add_f32 v13, v13, v215
  v_mfma_f32_16x16x32_f16 v[180:183], v[80:83], v[40:43], v[180:183]
  v_cvt_pk_bf16_f32 v10, 0, v10
  v_cvt_pk_bf16_f32 v11, 0, v11
  v_cvt_pk_bf16_f32 v12, 0, v12
  v_mfma_f32_16x16x32_f16 v[180:183], v[84:87], v[36:39], v[180:183]
  v_cvt_pk_bf16_f32 v13, 0, v13
  v_add_f32 v10, v10, v196
  v_add_f32 v11, v11, v197
  v_mfma_f32_16x16x32_f16 v[180:183], v[132:135], v[116:119], v[180:183]
  v_add_f32 v12, v12, v198
  v_add_f32 v13, v13, v199
  v_cvt_pk_bf16_f32 v10, v10, v11
  v_mfma_f32_16x16x32_f16 v[180:183], v[136:139], v[112:115], v[180:183]
  v_cvt_pk_bf16_f32 v11, v12, v13
  ds_write_b64 v236, v[10:11] offset:0
  s_waitcnt lgkmcnt(1)
  v_fma_f32 v14, v176, v240, v14
  v_mfma_f32_16x16x32_f16 v[180:183], v[140:143], v[108:111], v[180:183]
  v_fma_f32 v15, v177, v240, v15
  v_fma_f32 v16, v178, v240, v16
  v_fma_f32 v17, v179, v240, v17
  v_mfma_f32_16x16x32_f16 v[180:183], v[144:147], v[104:107], v[180:183]
  v_cvt_pk_bf16_f32 v14, 0, v14
  v_cvt_pk_bf16_f32 v15, 0, v15
  v_cvt_pk_bf16_f32 v16, 0, v16
  v_mfma_f32_16x16x32_f16 v[180:183], v[148:151], v[100:103], v[180:183]
  v_cvt_pk_bf16_f32 v17, 0, v17
  v_add_f32 v14, v14, v216
  v_add_f32 v15, v15, v217
  v_mfma_f32_16x16x32_f16 v[192:195], v[68:71], v[64:67], v[192:195]
  s_setprio 2
  v_add_f32 v16, v16, v218
  v_add_f32 v17, v17, v219
  v_cvt_pk_bf16_f32 v14, 0, v14
  v_mfma_f32_16x16x32_f16 v[192:195], v[72:75], v[60:63], v[192:195]
  v_cvt_pk_bf16_f32 v15, 0, v15
  v_cvt_pk_bf16_f32 v16, 0, v16
  v_cvt_pk_bf16_f32 v17, 0, v17
  v_mfma_f32_16x16x32_f16 v[192:195], v[76:79], v[56:59], v[192:195]
  v_add_f32 v14, v14, v200
  v_add_f32 v15, v15, v201
  v_add_f32 v16, v16, v202
  v_mfma_f32_16x16x32_f16 v[192:195], v[80:83], v[52:55], v[192:195]
  v_add_f32 v17, v17, v203
  v_cvt_pk_bf16_f32 v14, v14, v15
  v_cvt_pk_bf16_f32 v15, v16, v17
  v_mfma_f32_16x16x32_f16 v[192:195], v[84:87], v[48:51], v[192:195]
  ds_write_b64 v236, v[14:15] offset:512
  v_fma_f32 v18, v180, v240, v18
  v_fma_f32 v19, v181, v240, v19
  v_mfma_f32_16x16x32_f16 v[192:195], v[88:91], v[44:47], v[192:195]
  v_fma_f32 v20, v182, v240, v20
  v_fma_f32 v21, v183, v240, v21
  v_cvt_pk_bf16_f32 v18, 0, v18
  v_mfma_f32_16x16x32_f16 v[192:195], v[92:95], v[40:43], v[192:195]
  v_cvt_pk_bf16_f32 v19, 0, v19
  v_cvt_pk_bf16_f32 v20, 0, v20
  v_cvt_pk_bf16_f32 v21, 0, v21
  v_mfma_f32_16x16x32_f16 v[192:195], v[96:99], v[36:39], v[192:195]
  v_add_f32 v18, v18, v220
  v_add_f32 v19, v19, v221
  v_add_f32 v20, v20, v222
  v_mfma_f32_16x16x32_f16 v[192:195], v[132:135], v[128:131], v[192:195]
  v_add_f32 v21, v21, v223
  v_cvt_pk_bf16_f32 v18, 0, v18
  v_cvt_pk_bf16_f32 v19, 0, v19
  v_mfma_f32_16x16x32_f16 v[192:195], v[136:139], v[124:127], v[192:195]
  v_cvt_pk_bf16_f32 v20, 0, v20
  v_cvt_pk_bf16_f32 v21, 0, v21
  v_add_f32 v18, v18, v204
  v_mfma_f32_16x16x32_f16 v[192:195], v[140:143], v[120:123], v[192:195]
  s_setprio 1
  v_add_f32 v19, v19, v205
  v_add_f32 v20, v20, v206
  v_add_f32 v21, v21, v207
  v_mfma_f32_16x16x32_f16 v[192:195], v[144:147], v[116:119], v[192:195]
  v_cvt_pk_bf16_f32 v18, v18, v19
  v_cvt_pk_bf16_f32 v19, v20, v21
  ds_write_b64 v236, v[18:19] offset:1024
  v_mfma_f32_16x16x32_f16 v[192:195], v[148:151], v[112:115], v[192:195]
  v_mfma_f32_16x16x32_f16 v[192:195], v[152:155], v[108:111], v[192:195]
  v_mfma_f32_16x16x32_f16 v[192:195], v[156:159], v[104:107], v[192:195]
  v_mfma_f32_16x16x32_f16 v[192:195], v[160:163], v[100:103], v[192:195]
  s_setprio 0
  s_nop 6
  v_fma_f32 v22, v192, v240, v22
  v_fma_f32 v23, v193, v240, v23
  v_fma_f32 v24, v194, v240, v24
  v_fma_f32 v25, v195, v240, v25
  v_cvt_pk_bf16_f32 v22, 0, v22
  v_cvt_pk_bf16_f32 v23, 0, v23
  v_cvt_pk_bf16_f32 v24, 0, v24
  v_cvt_pk_bf16_f32 v25, 0, v25
  v_add_f32 v22, v22, v224
  v_add_f32 v23, v23, v225
  v_add_f32 v24, v24, v226
  v_add_f32 v25, v25, v227
  v_cvt_pk_bf16_f32 v22, 0, v22
  v_cvt_pk_bf16_f32 v23, 0, v23
  v_cvt_pk_bf16_f32 v24, 0, v24
  v_cvt_pk_bf16_f32 v25, 0, v25
  v_add_f32 v22, v22, v208
  v_add_f32 v23, v23, v209
  v_add_f32 v24, v24, v210
  v_add_f32 v25, v25, v211
  v_cvt_pk_bf16_f32 v22, v22, v23
  v_cvt_pk_bf16_f32 v23, v24, v25
  ds_write_b64 v236, v[22:23] offset:1536
  s_branch L_cvE
L_cvB:
  s_setprio 3
  ds_read_b64 v[18:19], v233 offset:512
  ds_read_b64 v[20:21], v233 offset:1024
  ds_read_b64 v[22:23], v233 offset:2560
  ds_read_b64 v[24:25], v233 offset:3072
  ds_read2_b32 v[68:69], v229 offset0:224 offset1:225
  ds_read2_b32 v[70:71], v229 offset0:226 offset1:227
  ds_read_b128 v[36:39], v228 offset:384
  ds_read2_b32 v[72:73], v229 offset0:96 offset1:97
  ds_read2_b32 v[74:75], v229 offset0:98 offset1:99
  ds_read_b128 v[40:43], v228 offset:896
  ds_read2_b32 v[76:77], v230 offset0:224 offset1:225
  ds_read2_b32 v[78:79], v230 offset0:226 offset1:227
  ds_read_b128 v[44:47], v228 offset:1408
  ds_read2_b32 v[80:81], v230 offset0:96 offset1:97
  s_waitcnt lgkmcnt(7)
  v_mfma_f32_16x16x32_f16 v[164:167], v[68:71], v[36:39], 0
  ds_read2_b32 v[82:83], v230 offset0:98 offset1:99
  ds_read_b128 v[48:51], v228 offset:1920
  s_waitcnt lgkmcnt(6)
  v_mfma_f32_16x16x32_f16 v[168:171], v[68:71], v[40:43], 0
  ds_read2_b32 v[84:85], v231 offset0:224 offset1:225
  ds_read2_b32 v[86:87], v231 offset0:226 offset1:227
  v_mfma_f32_16x16x32_f16 v[168:171], v[72:75], v[36:39], v[168:171]
  ds_read_b128 v[52:55], v228 offset:2432
  ds_read2_b32 v[88:89], v231 offset0:96 offset1:97
  s_waitcnt lgkmcnt(7)
  v_mfma_f32_16x16x32_f16 v[172:175], v[68:71], v[44:47], 0
  ds_read2_b32 v[90:91], v231 offset0:98 offset1:99
  ds_read_b128 v[56:59], v228 offset:2944
  v_mfma_f32_16x16x32_f16 v[172:175], v[72:75], v[40:43], v[172:175]
  ds_read2_b32 v[92:93], v232 offset0:224 offset1:225
  ds_read2_b32 v[94:95], v232 offset0:226 offset1:227
  v_mfma_f32_16x16x32_f16 v[172:175], v[76:79], v[36:39], v[172:175]
  ds_read_b128 v[60:63], v228 offset:3456
  ds_read2_b32 v[96:97], v232 offset0:96 offset1:97
  s_waitcnt lgkmcnt(8)
  v_mfma_f32_16x16x32_f16 v[176:179], v[68:71], v[48:51], 0
  ds_read2_b32 v[98:99], v232 offset0:98 offset1:99
  ds_read_b128 v[64:67], v228 offset:3968
  v_mfma_f32_16x16x32_f16 v[176:179], v[72:75], v[44:47], v[176:179]
  ds_read2_b32 v[132:133], v229 offset0:192 offset1:193
  ds_read2_b32 v[134:135], v229 offset0:194 offset1:195
  v_mfma_f32_16x16x32_f16 v[176:179], v[76:79], v[40:43], v[176:179]
  ds_read_b128 v[100:103], v228 offset:256
  ds_read2_b32 v[136:137], v229 offset0:64 offset1:65
  v_mfma_f32_16x16x32_f16 v[176:179], v[80:83], v[36:39], v[176:179]
  s_waitcnt lgkmcnt(8)
  ds_read2_b32 v[138:139], v229 offset0:66 offset1:67
  ds_read_b128 v[104:107], v228 offset:768
  v_mfma_f32_16x16x32_f16 v[180:183], v[68:71], v[52:55], 0
  ds_read2_b32 v[140:141], v230 offset0:192 offset1:193
  ds_read2_b32 v[142:143], v230 offset0:194 offset1:195
  v_mfma_f32_16x16x32_f16 v[180:183], v[72:75], v[48:51], v[180:183]
  ds_read_b128 v[108:111], v228 offset:1280
  ds_read2_b32 v[144:145], v230 offset0:64 offset1:65
  v_mfma_f32_16x16x32_f16 v[180:183], v[76:79], v[44:47], v[180:183]
  s_waitcnt lgkmcnt(8)
  ds_read2_b32 v[146:147], v230 offset0:66 offset1:67
  v_mfma_f32_16x16x32_f16 v[180:183], v[80:83], v[40:43], v[180:183]
  ds_read_b128 v[112:115], v228 offset:1792
  v_mfma_f32_16x16x32_f16 v[180:183], v[84:87], v[36:39], v[180:183]
  ds_read2_b32 v[148:149], v231 offset0:192 offset1:193
  v_lshlrev_b32 v28, 16, v26
  v_mfma_f32_16x16x32_f16 v[184:187], v[68:71], v[56:59], 0
  ds_read2_b32 v[150:151], v231 offset0:194 offset1:195
  v_cvt_f32_f16 v212, v18
  v_mfma_f32_16x16x32_f16 v[184:187], v[72:75], v[52:55], v[184:187]
  ds_read_b128 v[116:119], v228 offset:2304
  v_cvt_f32_f16_sdwa v213, v18 dst_sel:DWORD dst_unused:UNUSED_PAD src0_sel:WORD_1
  v_mfma_f32_16x16x32_f16 v[184:187], v[76:79], v[48:51], v[184:187]
  ds_read2_b32 v[152:153], v231 offset0:64 offset1:65
  s_waitcnt lgkmcnt(11)
  ds_read_b32 v250, v249
  v_cvt_f32_f16 v214, v19
  v_mfma_f32_16x16x32_f16 v[184:187], v[80:83], v[44:47], v[184:187]
  ds_read2_b32 v[154:155], v231 offset0:66 offset1:67
  v_cvt_f32_f16_sdwa v215, v19 dst_sel:DWORD dst_unused:UNUSED_PAD src0_sel:WORD_1
  v_mfma_f32_16x16x32_f16 v[184:187], v[84:87], v[40:43], v[184:187]
  ds_read_b128 v[120:123], v228 offset:2816
  v_cvt_f32_f16 v216, v20
  v_mfma_f32_16x16x32_f16 v[184:187], v[88:91], v[36:39], v[184:187]
  s_waitcnt lgkmcnt(5)
  ds_read2_b32 v[156:157], v232 offset0:192 offset1:193
  v_cvt_f32_f16_sdwa v217, v20 dst_sel:DWORD dst_unused:UNUSED_PAD src0_sel:WORD_1
  v_mfma_f32_16x16x32_f16 v[188:191], v[68:71], v[60:63], 0
  ds_read2_b32 v[158:159], v232 offset0:194 offset1:195
  v_cvt_f32_f16 v218, v21
  v_mfma_f32_16x16x32_f16 v[188:191], v[72:75], v[56:59], v[188:191]
  ds_read_b128 v[124:127], v228 offset:3328
  s_waitcnt lgkmcnt(5)
  s_mov_b32 s79, 0
LC_xsB:
  v_readfirstlane_b32 s78, v250
  s_lshr_b32 s77, s79, 22
  s_or_b32 s78, s78, s77
  s_cbranch_scc1 LC_xoB
  s_waitcnt lgkmcnt(0)
  ds_read_b32 v250, v249
  s_add_u32 s79, s79, 1
  s_waitcnt lgkmcnt(0)
  s_branch LC_xsB
LC_xoB:
  s_add_u32 s60, s91, 0
  buffer_load_dwordx2 v[10:11], v210, s[56:59], s60 offen offset:2048 sc1
  s_add_u32 s60, s91, 4096
  buffer_load_dwordx2 v[12:13], v210, s[56:59], s60 offen offset:0 sc1
  s_add_u32 s60, s91, 8192
  buffer_load_dwordx2 v[14:15], v210, s[56:59], s60 offen offset:2048 sc1
  s_add_u32 s60, s91, 12288
  buffer_load_dwordx2 v[16:17], v210, s[56:59], s60 offen offset:0 sc1
  v_cvt_f32_f16_sdwa v219, v21 dst_sel:DWORD dst_unused:UNUSED_PAD src0_sel:WORD_1
  v_mfma_f32_16x16x32_f16 v[188:191], v[76:79], v[52:55], v[188:191]
  ds_read2_b32 v[160:161], v232 offset0:64 offset1:65
  v_cvt_f32_f16 v220, v22
  v_mfma_f32_16x16x32_f16 v[188:191], v[80:83], v[48:51], v[188:191]
  ds_read2_b32 v[162:163], v232 offset0:66 offset1:67
  v_cvt_f32_f16_sdwa v221, v22 dst_sel:DWORD dst_unused:UNUSED_PAD src0_sel:WORD_1
  v_mfma_f32_16x16x32_f16 v[188:191], v[84:87], v[44:47], v[188:191]
  ds_read_b128 v[128:131], v228 offset:3840
  v_cvt_f32_f16 v222, v23
  v_mfma_f32_16x16x32_f16 v[188:191], v[88:91], v[40:43], v[188:191]
  v_cvt_f32_f16_sdwa v223, v23 dst_sel:DWORD dst_unused:UNUSED_PAD src0_sel:WORD_1
  v_mfma_f32_16x16x32_f16 v[188:191], v[92:95], v[36:39], v[188:191]
  v_cvt_f32_f16 v224, v24
  v_mfma_f32_16x16x32_f16 v[192:195], v[68:71], v[64:67], 0
  ds_read2_b32 v[68:69], v229 offset0:160 offset1:161
  v_cvt_f32_f16_sdwa v225, v24 dst_sel:DWORD dst_unused:UNUSED_PAD src0_sel:WORD_1
  v_mfma_f32_16x16x32_f16 v[192:195], v[72:75], v[60:63], v[192:195]
  ds_read2_b32 v[70:71], v229 offset0:162 offset1:163
  v_cvt_f32_f16 v226, v25
  v_mfma_f32_16x16x32_f16 v[192:195], v[76:79], v[56:59], v[192:195]
  v_cvt_f32_f16_sdwa v227, v25 dst_sel:DWORD dst_unused:UNUSED_PAD src0_sel:WORD_1
  v_mfma_f32_16x16x32_f16 v[192:195], v[80:83], v[52:55], v[192:195]
  v_mul_f32 v212, v212, v28
  v_mfma_f32_16x16x32_f16 v[192:195], v[84:87], v[48:51], v[192:195]
  v_mul_f32 v213, v213, v28
  v_mfma_f32_16x16x32_f16 v[192:195], v[88:91], v[44:47], v[192:195]
  v_mul_f32 v214, v214, v28
  v_mfma_f32_16x16x32_f16 v[192:195], v[92:95], v[40:43], v[192:195]
  v_mul_f32 v215, v215, v28
  v_mfma_f32_16x16x32_f16 v[192:195], v[96:99], v[36:39], v[192:195]
  ds_read_b128 v[36:39], v228 offset:128
  v_mul_f32 v216, v216, v28
  v_mfma_f32_16x16x32_f16 v[164:167], v[132:135], v[100:103], v[164:167]
  ds_read2_b32 v[80:81], v230 offset0:32 offset1:33
  s_setprio 2
  v_mul_f32 v217, v217, v28
  v_mfma_f32_16x16x32_f16 v[168:171], v[132:135], v[104:107], v[168:171]
  ds_read2_b32 v[82:83], v230 offset0:34 offset1:35
  v_mul_f32 v218, v218, v28
  v_mfma_f32_16x16x32_f16 v[168:171], v[136:139], v[100:103], v[168:171]
  ds_read_b128 v[48:51], v228 offset:1664
  v_mul_f32 v219, v219, v28
  v_mfma_f32_16x16x32_f16 v[172:175], v[132:135], v[108:111], v[172:175]
  s_waitcnt lgkmcnt(4)
  ds_read2_b32 v[72:73], v229 offset0:32 offset1:33
  v_mul_f32 v220, v220, v28
  v_mfma_f32_16x16x32_f16 v[172:175], v[136:139], v[104:107], v[172:175]
  ds_read2_b32 v[74:75], v229 offset0:34 offset1:35
  s_mov_b32 s92, s24
  s_mov_b32 s93, s25
  s_mov_b32 s94, 0x21c000
  s_mov_b32 s95, 0x20000
  v_lshlrev_b32 v251, 6, v1
  s_lshl_b32 s60, s86, 2
  s_add_u32 s60, s60, s84
  s_lshl_b32 s60, s60, 12
  buffer_load_dword v245, v251, s[92:95], s60 offen
  v_mul_f32 v221, v221, v28
  v_mfma_f32_16x16x32_f16 v[172:175], v[140:143], v[100:103], v[172:175]
  ds_read_b128 v[40:43], v228 offset:640
  v_mul_f32 v222, v222, v28
  v_mfma_f32_16x16x32_f16 v[176:179], v[132:135], v[112:115], v[176:179]
  ds_read2_b32 v[76:77], v230 offset0:160 offset1:161
  v_mul_f32 v223, v223, v28
  v_mfma_f32_16x16x32_f16 v[176:179], v[136:139], v[108:111], v[176:179]
  ds_read2_b32 v[78:79], v230 offset0:162 offset1:163
  v_mul_f32 v224, v224, v28
  v_mfma_f32_16x16x32_f16 v[176:179], v[140:143], v[104:107], v[176:179]
  ds_read_b128 v[44:47], v228 offset:1152
  v_mul_f32 v225, v225, v28
  v_mfma_f32_16x16x32_f16 v[176:179], v[144:147], v[100:103], v[176:179]
  ds_read2_b32 v[84:85], v231 offset0:160 offset1:161
  v_mul_f32 v226, v226, v28
  v_mfma_f32_16x16x32_f16 v[180:183], v[132:135], v[116:119], v[180:183]
  ds_read2_b32 v[86:87], v231 offset0:162 offset1:163
  v_mul_f32 v227, v227, v28
  v_mfma_f32_16x16x32_f16 v[180:183], v[136:139], v[112:115], v[180:183]
  ds_read_b128 v[52:55], v228 offset:2176
  v_cvt_pk_bf16_f32 v212, 0, v212
  v_mfma_f32_16x16x32_f16 v[180:183], v[140:143], v[108:111], v[180:183]
  ds_read2_b32 v[96:97], v232 offset0:32 offset1:33
  v_cvt_pk_bf16_f32 v213, 0, v213
  v_mfma_f32_16x16x32_f16 v[180:183], v[144:147], v[104:107], v[180:183]
  s_waitcnt lgkmcnt(4)
  ds_read2_b32 v[98:99], v232 offset0:34 offset1:35
  v_cvt_pk_bf16_f32 v214, 0, v214
  v_mfma_f32_16x16x32_f16 v[180:183], v[148:151], v[100:103], v[180:183]
  ds_read_b128 v[64:67], v228 offset:3712
  v_cvt_pk_bf16_f32 v215, 0, v215
  v_mfma_f32_16x16x32_f16 v[184:187], v[132:135], v[120:123], v[184:187]
  ds_read2_b32 v[92:93], v232 offset0:160 offset1:161
  v_cvt_pk_bf16_f32 v216, 0, v216
  v_mfma_f32_16x16x32_f16 v[184:187], v[136:139], v[116:119], v[184:187]
  ds_read2_b32 v[94:95], v232 offset0:162 offset1:163
  v_cvt_pk_bf16_f32 v217, 0, v217
  v_mfma_f32_16x16x32_f16 v[184:187], v[140:143], v[112:115], v[184:187]
  ds_read_b128 v[60:63], v228 offset:3200
  v_cvt_pk_bf16_f32 v218, 0, v218
  v_mfma_f32_16x16x32_f16 v[184:187], v[144:147], v[108:111], v[184:187]
  ds_read2_b32 v[88:89], v231 offset0:32 offset1:33
  v_cvt_pk_bf16_f32 v219, 0, v219
  v_mfma_f32_16x16x32_f16 v[184:187], v[148:151], v[104:107], v[184:187]
  ds_read2_b32 v[90:91], v231 offset0:34 offset1:35
  v_cvt_pk_bf16_f32 v220, 0, v220
  v_mfma_f32_16x16x32_f16 v[184:187], v[152:155], v[100:103], v[184:187]
  ds_read_b128 v[56:59], v228 offset:2688
  v_cvt_pk_bf16_f32 v221, 0, v221
  v_mfma_f32_16x16x32_f16 v[188:191], v[132:135], v[124:127], v[188:191]
  v_cvt_pk_bf16_f32 v222, 0, v222
  v_mfma_f32_16x16x32_f16 v[188:191], v[136:139], v[120:123], v[188:191]
  v_cvt_pk_bf16_f32 v223, 0, v223
  v_mfma_f32_16x16x32_f16 v[188:191], v[140:143], v[116:119], v[188:191]
  v_cvt_pk_bf16_f32 v224, 0, v224
  v_mfma_f32_16x16x32_f16 v[188:191], v[144:147], v[112:115], v[188:191]
  v_cvt_pk_bf16_f32 v225, 0, v225
  v_mfma_f32_16x16x32_f16 v[188:191], v[148:151], v[108:111], v[188:191]
  v_cvt_pk_bf16_f32 v226, 0, v226
  v_mfma_f32_16x16x32_f16 v[188:191], v[152:155], v[104:107], v[188:191]
  v_cvt_pk_bf16_f32 v227, 0, v227
  v_mfma_f32_16x16x32_f16 v[188:191], v[156:159], v[100:103], v[188:191]
  v_mfma_f32_16x16x32_f16 v[192:195], v[132:135], v[128:131], v[192:195]
  ds_read2_b32 v[132:133], v229 offset0:128 offset1:129
  ds_read2_b32 v[134:135], v229 offset0:130 offset1:131
  v_mfma_f32_16x16x32_f16 v[192:195], v[160:163], v[100:103], v[192:195]
  s_waitcnt lgkmcnt(2)
  ds_read_b128 v[100:103], v228 offset:0
  v_mfma_f32_16x16x32_f16 v[192:195], v[136:139], v[124:127], v[192:195]
  v_mfma_f32_16x16x32_f16 v[192:195], v[156:159], v[104:107], v[192:195]
  v_mfma_f32_16x16x32_f16 v[192:195], v[140:143], v[120:123], v[192:195]
  v_mfma_f32_16x16x32_f16 v[192:195], v[152:155], v[108:111], v[192:195]
  v_mfma_f32_16x16x32_f16 v[192:195], v[144:147], v[116:119], v[192:195]
  ds_read2_b32 v[144:145], v230 offset0:0 offset1:1
  ds_read2_b32 v[146:147], v230 offset0:2 offset1:3
  v_mfma_f32_16x16x32_f16 v[192:195], v[148:151], v[112:115], v[192:195]
  ds_read_b128 v[112:115], v228 offset:1536
  ds_read2_b32 v[136:137], v229 offset0:0 offset1:1
  v_mfma_f32_16x16x32_f16 v[164:167], v[68:71], v[36:39], v[164:167]
  ds_read2_b32 v[138:139], v229 offset0:2 offset1:3
  ds_read_b128 v[104:107], v228 offset:512
  v_mfma_f32_16x16x32_f16 v[176:179], v[68:71], v[48:51], v[176:179]
  ds_read2_b32 v[140:141], v230 offset0:128 offset1:129
  ds_read2_b32 v[142:143], v230 offset0:130 offset1:131
  v_mfma_f32_16x16x32_f16 v[176:179], v[72:75], v[44:47], v[176:179]
  ds_read_b128 v[108:111], v228 offset:1024
  ds_read2_b32 v[148:149], v231 offset0:128 offset1:129
  v_mfma_f32_16x16x32_f16 v[176:179], v[76:79], v[40:43], v[176:179]
  ds_read2_b32 v[150:151], v231 offset0:130 offset1:131
  s_waitcnt lgkmcnt(9)
  ds_read_b128 v[116:119], v228 offset:2048
  v_mfma_f32_16x16x32_f16 v[176:179], v[80:83], v[36:39], v[176:179]
  ds_read2_b32 v[160:161], v232 offset0:0 offset1:1
  ds_read2_b32 v[162:163], v232 offset0:2 offset1:3
  v_mfma_f32_16x16x32_f16 v[180:183], v[68:71], v[52:55], v[180:183]
  ds_read_b128 v[128:131], v228 offset:3584
  ds_read2_b32 v[156:157], v232 offset0:128 offset1:129
  v_mfma_f32_16x16x32_f16 v[180:183], v[72:75], v[48:51], v[180:183]
  s_waitcnt lgkmcnt(8)
  ds_read2_b32 v[158:159], v232 offset0:130 offset1:131
  ds_read_b128 v[124:127], v228 offset:3072
  v_mfma_f32_16x16x32_f16 v[180:183], v[76:79], v[44:47], v[180:183]
  ds_read2_b32 v[152:153], v231 offset0:0 offset1:1
  ds_read2_b32 v[154:155], v231 offset0:2 offset1:3
  v_mfma_f32_16x16x32_f16 v[180:183], v[80:83], v[40:43], v[180:183]
  ds_read_b128 v[120:123], v228 offset:2560
  s_setprio 1
  v_mfma_f32_16x16x32_f16 v[180:183], v[84:87], v[36:39], v[180:183]
  v_mfma_f32_16x16x32_f16 v[192:195], v[68:71], v[64:67], v[192:195]
  v_mfma_f32_16x16x32_f16 v[192:195], v[72:75], v[60:63], v[192:195]
  v_mfma_f32_16x16x32_f16 v[192:195], v[76:79], v[56:59], v[192:195]
  v_mfma_f32_16x16x32_f16 v[192:195], v[80:83], v[52:55], v[192:195]
  v_mfma_f32_16x16x32_f16 v[192:195], v[84:87], v[48:51], v[192:195]
  v_mfma_f32_16x16x32_f16 v[192:195], v[88:91], v[44:47], v[192:195]
  v_mfma_f32_16x16x32_f16 v[192:195], v[92:95], v[40:43], v[192:195]
  v_mfma_f32_16x16x32_f16 v[192:195], v[96:99], v[36:39], v[192:195]
  v_mfma_f32_16x16x32_f16 v[164:167], v[132:135], v[100:103], v[164:167]
  v_mfma_f32_16x16x32_f16 v[176:179], v[132:135], v[112:115], v[176:179]
  s_waitcnt lgkmcnt(0)
  v_mfma_f32_16x16x32_f16 v[176:179], v[136:139], v[108:111], v[176:179]
  v_mfma_f32_16x16x32_f16 v[176:179], v[140:143], v[104:107], v[176:179]
  s_nop 3
  v_mul_f32 v164, v164, v240
  v_mfma_f32_16x16x32_f16 v[176:179], v[144:147], v[100:103], v[176:179]
  v_mul_f32 v165, v165, v240
  v_mfma_f32_16x16x32_f16 v[180:183], v[132:135], v[116:119], v[180:183]
  v_mul_f32 v166, v166, v240
  v_mfma_f32_16x16x32_f16 v[180:183], v[136:139], v[112:115], v[180:183]
  s_waitcnt vmcnt(1)
  v_mul_f32 v167, v167, v240
  ds_write_b128 v234, v[164:167] offset:0
  v_mfma_f32_16x16x32_f16 v[180:183], v[140:143], v[108:111], v[180:183]
  v_lshlrev_b32 v196, 16, v10
  v_and_b32 v197, s82, v10
  v_mfma_f32_16x16x32_f16 v[180:183], v[144:147], v[104:107], v[180:183]
  v_lshlrev_b32 v198, 16, v11
  v_and_b32 v199, s82, v11
  v_mfma_f32_16x16x32_f16 v[180:183], v[148:151], v[100:103], v[180:183]
  v_lshlrev_b32 v200, 16, v12
  v_and_b32 v201, s82, v12
  v_mfma_f32_16x16x32_f16 v[192:195], v[132:135], v[128:131], v[192:195]
  v_lshlrev_b32 v202, 16, v13
  v_and_b32 v203, s82, v13
  v_mfma_f32_16x16x32_f16 v[192:195], v[136:139], v[124:127], v[192:195]
  v_lshlrev_b32 v204, 16, v14
  v_and_b32 v205, s82, v14
  v_mfma_f32_16x16x32_f16 v[192:195], v[140:143], v[120:123], v[192:195]
  v_lshlrev_b32 v206, 16, v15
  v_and_b32 v207, s82, v15
  v_mfma_f32_16x16x32_f16 v[192:195], v[144:147], v[116:119], v[192:195]
  v_lshlrev_b32 v208, 16, v16
  v_and_b32 v209, s82, v16
  v_mfma_f32_16x16x32_f16 v[192:195], v[148:151], v[112:115], v[192:195]
  s_setprio 0
  v_lshlrev_b32 v210, 16, v17
  v_and_b32 v211, s82, v17
  v_mfma_f32_16x16x32_f16 v[192:195], v[152:155], v[108:111], v[192:195]
  v_mul_f32 v176, v176, v240
  v_mul_f32 v177, v177, v240
  v_mfma_f32_16x16x32_f16 v[192:195], v[156:159], v[104:107], v[192:195]
  v_mul_f32 v178, v178, v240
  v_mul_f32 v179, v179, v240
  v_mfma_f32_16x16x32_f16 v[192:195], v[160:163], v[100:103], v[192:195]
  ds_write_b128 v234, v[176:179] offset:1024
  v_mul_f32 v180, v180, v240
  v_mfma_f32_16x16x32_f16 v[168:171], v[68:71], v[40:43], v[168:171]
  v_mul_f32 v181, v181, v240
  v_mul_f32 v182, v182, v240
  v_mfma_f32_16x16x32_f16 v[168:171], v[72:75], v[36:39], v[168:171]
  v_mul_f32 v183, v183, v240
  ds_write_b128 v234, v[180:183] offset:2048
  v_mfma_f32_16x16x32_f16 v[168:171], v[132:135], v[104:107], v[168:171]
  v_mul_f32 v192, v192, v240
  v_mul_f32 v193, v193, v240
  v_mfma_f32_16x16x32_f16 v[168:171], v[136:139], v[100:103], v[168:171]
  v_mul_f32 v194, v194, v240
  v_mul_f32 v195, v195, v240
  v_mfma_f32_16x16x32_f16 v[172:175], v[68:71], v[44:47], v[172:175]
  ds_write_b128 v234, v[192:195] offset:3072
  v_mfma_f32_16x16x32_f16 v[172:175], v[72:75], v[40:43], v[172:175]
  s_waitcnt lgkmcnt(0)
  s_barrier
  s_setprio 3
  ds_read_b128 v[10:13], v235 offset:0
  ds_read_b128 v[14:17], v235 offset:1024
  ds_read_b128 v[18:21], v235 offset:2048
  v_mfma_f32_16x16x32_f16 v[172:175], v[76:79], v[36:39], v[172:175]
  ds_read_b128 v[22:25], v235 offset:3072
  v_mfma_f32_16x16x32_f16 v[172:175], v[132:135], v[108:111], v[172:175]
  v_mfma_f32_16x16x32_f16 v[172:175], v[136:139], v[104:107], v[172:175]
  s_cmp_eq_u32 s3, 4
  s_cselect_b64 exec, 65535, 0
  v_mov_b32 v244, 0
  buffer_atomic_add v244, v246, s[36:39], 0 offen offset:8 sc0 sc1
  s_mov_b64 exec, -1
  v_mfma_f32_16x16x32_f16 v[172:175], v[140:143], v[100:103], v[172:175]
  s_waitcnt lgkmcnt(3)
  v_fma_f32 v10, v168, v240, v10
  v_fma_f32 v11, v169, v240, v11
  v_fma_f32 v12, v170, v240, v12
  v_mfma_f32_16x16x32_f16 v[184:187], v[68:71], v[56:59], v[184:187]
  v_fma_f32 v13, v171, v240, v13
  v_cvt_pk_bf16_f32 v10, 0, v10
  v_cvt_pk_bf16_f32 v11, 0, v11
  v_mfma_f32_16x16x32_f16 v[184:187], v[72:75], v[52:55], v[184:187]
  v_cvt_pk_bf16_f32 v12, 0, v12
  v_cvt_pk_bf16_f32 v13, 0, v13
  v_add_f32 v10, v10, v212
  v_mfma_f32_16x16x32_f16 v[184:187], v[76:79], v[48:51], v[184:187]
  v_add_f32 v11, v11, v213
  v_add_f32 v12, v12, v214
  v_add_f32 v13, v13, v215
  v_mfma_f32_16x16x32_f16 v[184:187], v[80:83], v[44:47], v[184:187]
  v_cvt_pk_bf16_f32 v10, 0, v10
  v_cvt_pk_bf16_f32 v11, 0, v11
  v_cvt_pk_bf16_f32 v12, 0, v12
  v_mfma_f32_16x16x32_f16 v[184:187], v[84:87], v[40:43], v[184:187]
  v_cvt_pk_bf16_f32 v13, 0, v13
  v_add_f32 v10, v10, v196
  v_add_f32 v11, v11, v197
  v_mfma_f32_16x16x32_f16 v[184:187], v[88:91], v[36:39], v[184:187]
  v_add_f32 v12, v12, v198
  v_add_f32 v13, v13, v199
  v_cvt_pk_bf16_f32 v10, v10, v11
  v_mfma_f32_16x16x32_f16 v[184:187], v[132:135], v[120:123], v[184:187]
  v_cvt_pk_bf16_f32 v11, v12, v13
  ds_write_b64 v236, v[10:11] offset:0
  s_waitcnt lgkmcnt(1)
  v_fma_f32 v14, v172, v240, v14
  v_mfma_f32_16x16x32_f16 v[184:187], v[136:139], v[116:119], v[184:187]
  v_fma_f32 v15, v173, v240, v15
  v_fma_f32 v16, v174, v240, v16
  v_fma_f32 v17, v175, v240, v17
  v_mfma_f32_16x16x32_f16 v[184:187], v[140:143], v[112:115], v[184:187]
  v_cvt_pk_bf16_f32 v14, 0, v14
  v_cvt_pk_bf16_f32 v15, 0, v15
  v_cvt_pk_bf16_f32 v16, 0, v16
  v_mfma_f32_16x16x32_f16 v[184:187], v[144:147], v[108:111], v[184:187]
  v_cvt_pk_bf16_f32 v17, 0, v17
  v_add_f32 v14, v14, v216
  v_add_f32 v15, v15, v217
  v_mfma_f32_16x16x32_f16 v[184:187], v[148:151], v[104:107], v[184:187]
  s_setprio 2
  v_add_f32 v16, v16, v218
  v_add_f32 v17, v17, v219
  v_cvt_pk_bf16_f32 v14, 0, v14
  v_mfma_f32_16x16x32_f16 v[184:187], v[152:155], v[100:103], v[184:187]
  v_cvt_pk_bf16_f32 v15, 0, v15
  v_cvt_pk_bf16_f32 v16, 0, v16
  v_cvt_pk_bf16_f32 v17, 0, v17
  v_mfma_f32_16x16x32_f16 v[188:191], v[68:71], v[60:63], v[188:191]
  v_add_f32 v14, v14, v200
  v_add_f32 v15, v15, v201
  v_add_f32 v16, v16, v202
  v_mfma_f32_16x16x32_f16 v[188:191], v[72:75], v[56:59], v[188:191]
  v_add_f32 v17, v17, v203
  v_cvt_pk_bf16_f32 v14, v14, v15
  v_cvt_pk_bf16_f32 v15, v16, v17
  v_mfma_f32_16x16x32_f16 v[188:191], v[76:79], v[52:55], v[188:191]
  ds_write_b64 v236, v[14:15] offset:512
  v_fma_f32 v18, v184, v240, v18
  v_fma_f32 v19, v185, v240, v19
  v_mfma_f32_16x16x32_f16 v[188:191], v[80:83], v[48:51], v[188:191]
  v_fma_f32 v20, v186, v240, v20
  v_fma_f32 v21, v187, v240, v21
  v_cvt_pk_bf16_f32 v18, 0, v18
  v_mfma_f32_16x16x32_f16 v[188:191], v[84:87], v[44:47], v[188:191]
  v_cvt_pk_bf16_f32 v19, 0, v19
  v_cvt_pk_bf16_f32 v20, 0, v20
  v_cvt_pk_bf16_f32 v21, 0, v21
  v_mfma_f32_16x16x32_f16 v[188:191], v[88:91], v[40:43], v[188:191]
  v_add_f32 v18, v18, v220
  v_add_f32 v19, v19, v221
  v_add_f32 v20, v20, v222
  v_mfma_f32_16x16x32_f16 v[188:191], v[92:95], v[36:39], v[188:191]
  v_add_f32 v21, v21, v223
  v_cvt_pk_bf16_f32 v18, 0, v18
  v_cvt_pk_bf16_f32 v19, 0, v19
  v_mfma_f32_16x16x32_f16 v[188:191], v[132:135], v[124:127], v[188:191]
  v_cvt_pk_bf16_f32 v20, 0, v20
  v_cvt_pk_bf16_f32 v21, 0, v21
  v_add_f32 v18, v18, v204
  v_mfma_f32_16x16x32_f16 v[188:191], v[136:139], v[120:123], v[188:191]
  s_setprio 1
  v_add_f32 v19, v19, v205
  v_add_f32 v20, v20, v206
  v_add_f32 v21, v21, v207
  v_mfma_f32_16x16x32_f16 v[188:191], v[140:143], v[116:119], v[188:191]
  v_cvt_pk_bf16_f32 v18, v18, v19
  v_cvt_pk_bf16_f32 v19, v20, v21
  ds_write_b64 v236, v[18:19] offset:1024
  v_mfma_f32_16x16x32_f16 v[188:191], v[144:147], v[112:115], v[188:191]
  v_mfma_f32_16x16x32_f16 v[188:191], v[148:151], v[108:111], v[188:191]
  v_mfma_f32_16x16x32_f16 v[188:191], v[152:155], v[104:107], v[188:191]
  v_mfma_f32_16x16x32_f16 v[188:191], v[156:159], v[100:103], v[188:191]
  s_setprio 0
  s_nop 6
  v_fma_f32 v22, v188, v240, v22
  v_fma_f32 v23, v189, v240, v23
  v_fma_f32 v24, v190, v240, v24
  v_fma_f32 v25, v191, v240, v25
  v_cvt_pk_bf16_f32 v22, 0, v22
  v_cvt_pk_bf16_f32 v23, 0, v23
  v_cvt_pk_bf16_f32 v24, 0, v24
  v_cvt_pk_bf16_f32 v25, 0, v25
  v_add_f32 v22, v22, v224
  v_add_f32 v23, v23, v225
  v_add_f32 v24, v24, v226
  v_add_f32 v25, v25, v227
  v_cvt_pk_bf16_f32 v22, 0, v22
  v_cvt_pk_bf16_f32 v23, 0, v23
  v_cvt_pk_bf16_f32 v24, 0, v24
  v_cvt_pk_bf16_f32 v25, 0, v25
  v_add_f32 v22, v22, v208
  v_add_f32 v23, v23, v209
  v_add_f32 v24, v24, v210
  v_add_f32 v25, v25, v211
  v_cvt_pk_bf16_f32 v22, v22, v23
  v_cvt_pk_bf16_f32 v23, v24, v25
  ds_write_b64 v236, v[22:23] offset:1536
L_cvE:
  s_setprio 0
  s_cmp_lg_u32 s3, 4
  s_cbranch_scc1 LC_p0
  s_waitcnt vmcnt(0)
  v_cmp_gt_u32 vcc, 6, v244
  s_and_b32 s78, vcc_lo, 65535
  s_cbranch_scc0 LC_p0
  s_mov_b64 exec, 65535
  v_mov_b32 v244, 0
  buffer_atomic_add v244, v246, s[36:39], 0 offen offset:8 sc0 sc1
  s_mov_b64 exec, -1
LC_p0:
  s_waitcnt lgkmcnt(0)
  s_barrier
  ds_read_b64_tr_b16 v[52:53], v237 offset:0
  ds_read_b64_tr_b16 v[54:55], v237 offset:32
  ds_read_b64_tr_b16 v[56:57], v237 offset:1024
  ds_read_b64_tr_b16 v[58:59], v237 offset:1056
  s_waitcnt lgkmcnt(2)
  buffer_store_dwordx4 v[52:55], v238, s[40:43], s100 offen offset:0 sc1
  s_add_u32 s100, s100, 8192
  s_waitcnt lgkmcnt(0)
  buffer_store_dwordx4 v[56:59], v238, s[40:43], s100 offen offset:0 sc1
  s_cmp_lg_u32 s3, 4
  s_cbranch_scc1 LP_doneP
  s_waitcnt vmcnt(2)
  v_cmp_gt_u32 vcc, 6, v244
  s_and_b32 s78, vcc_lo, 65535
  s_cbranch_scc0 LP_doneP
  s_mov_b64 exec, 65535
  v_mov_b32 v244, 0
  buffer_atomic_add v244, v246, s[36:39], 0 offen offset:8 sc0 sc1
  s_mov_b64 exec, -1
  s_mov_b32 s79, 0
LP_loopP:
  s_waitcnt vmcnt(0)
  v_cmp_gt_u32 vcc, 6, v244
  s_and_b32 s78, vcc_lo, 65535
  s_cbranch_scc0 LP_doneP
  s_mov_b64 exec, 65535
  v_mov_b32 v244, 0
  buffer_atomic_add v244, v246, s[36:39], 0 offen offset:8 sc0 sc1
  s_mov_b64 exec, -1
  s_add_u32 s79, s79, 1
  s_cmp_lt_u32 s79, 100000
  s_cbranch_scc1 LP_loopP
  s_waitcnt vmcnt(0)
LP_doneP:
  s_barrier
  s_cmp_lt_u32 s3, 4
  s_cbranch_scc1 LA_ne
  s_sub_u32 s60, s3, 4
  s_lshl_b32 s60, s60, 10
  v_lshlrev_b32 v2, 4, v1
  v_add_u32 v4, s34, v2
  v_add_u32 v5, 41984, v4
  s_mov_b32 s61, s60
  s_add_u32 m0, s60, 8192
  s_nop 0
  buffer_load_dwordx4 v4, s[44:47], s61 offen sc1 lds
  s_add_u32 m0, s60, 12288
  s_nop 0
  buffer_load_dwordx4 v5, s[44:47], s61 offen sc1 lds
  s_add_u32 s61, s61, 4096
  s_add_u32 m0, s60, 16384
  s_nop 0
  buffer_load_dwordx4 v4, s[44:47], s61 offen sc1 lds
  s_add_u32 m0, s60, 20480
  s_nop 0
  buffer_load_dwordx4 v5, s[44:47], s61 offen sc1 lds
  s_add_u32 s61, s61, 4096
  s_add_u32 m0, s60, 24576
  s_nop 0
  buffer_load_dwordx4 v4, s[44:47], s61 offen sc1 lds
  s_add_u32 m0, s60, 28672
  s_nop 0
  buffer_load_dwordx4 v5, s[44:47], s61 offen sc1 lds
  s_add_u32 s61, s61, 4096
  s_add_u32 m0, s60, 32768
  s_nop 0
  buffer_load_dwordx4 v4, s[44:47], s61 offen sc1 lds
  s_add_u32 m0, s60, 36864
  s_nop 0
  buffer_load_dwordx4 v5, s[44:47], s61 offen sc1 lds
  s_add_u32 s61, s61, 4096
  s_add_u32 m0, s60, 40960
  s_nop 0
  buffer_load_dwordx4 v4, s[44:47], s61 offen sc1 lds
  s_add_u32 m0, s60, 45056
  s_nop 0
  buffer_load_dwordx4 v5, s[44:47], s61 offen sc1 lds
  s_waitcnt vmcnt(10)
  s_branch LA_ne1
LA_ne:
  s_waitcnt vmcnt(0)
LA_ne1:
  s_barrier
  s_cmp_lg_u32 s3, 0
  s_cbranch_scc1 L_ffn
  s_and_b32 s78, s86, 15
  s_lshl_b32 s78, s78, 10
  s_mov_b64 exec, 255
  buffer_atomic_add v248, v247, s[36:39], s78 offen offset:4 sc1
  s_mov_b64 exec, -1
L_ffn:
  v_lshlrev_b32 v2, 4, v1
  v_add_u32 v3, 4096, v2
  s_bfe_u32 s61, s2, 0x20001
  s_lshl_b32 s61, s61, 3
  s_bfe_u32 s66, s2, 0x30003
  s_add_u32 s61, s61, s66
  s_and_b32 s60, s2, 1
  s_lshl_b32 s60, s60, 2
  s_lshr_b32 s66, s2, 6
  s_add_u32 s60, s60, s66
  s_add_u32 s48, s30, 0xa00000
  s_addc_u32 s49, s31, 0
  s_mov_b32 s50, 0x700000
  s_mov_b32 s51, 0x20000
  s_add_u32 s52, s30, 0x780000
  s_addc_u32 s53, s31, 0
  s_mov_b32 s54, 0x230000
  s_mov_b32 s55, 0x20000
  s_mul_i32 s62, s60, 56
  s_add_u32 s62, s62, s3
  s_mul_i32 s62, s62, 5120
  s_cmp_ge_u32 s3, 4
  s_cbranch_scc1 L3_help
  s_lshr_b32 s78, s2, 3
  s_and_b32 s78, s78, 7
  s_lshl_b32 s78, s78, 7
  v_lshl_add_u32 v91, v1, 10, s78
  s_cmp_lg_u32 s3, 0
  s_cbranch_scc1 L3_np
  s_mov_b64 exec, 65535
  v_mov_b32 v90, 0
  buffer_atomic_add v90, v91, s[36:39], 0 offen offset:4 sc0 sc1
  s_mov_b64 exec, -1
L3_np:
  v_add_u32 v4, 0x10000, v2
  v_add_u32 v5, 0x20000, v2
  s_lshl_b32 s66, s32, 2
  s_add_u32 s66, s66, s3
  s_lshl_b32 s65, s18, 6
  s_mul_i32 s64, s66, 114688
  s_lshl_b32 s66, s66, 8
  s_mul_i32 s67, s33, 2560
  s_add_u32 s64, s64, s67
  s_mul_i32 s71, s33, 1536
  s_sub_u32 s71, 38912, s71
  s_and_b32 s70, s33, 3
  s_cmp_eq_u32 s70, 0
  s_cselect_b32 s70, 0, 1.0
  v_lshrrev_b32 v12, 4, v1
  v_and_b32 v13, 15, v1
  v_lshlrev_b32 v13, 4, v13
  v_lshl_add_u32 v10, v12, 14, v13
  v_add_u32 v10, s66, v10
  v_and_b32 v12, 1, v12
  v_mul_u32_u24 v12, 57344, v12
  v_lshrrev_b32 v14, 5, v1
  v_lshl_add_u32 v12, v14, 8, v12
  v_add_u32 v8, v13, v12
  v_mov_b32 v88, s80
  v_mov_b32 v89, s80
  s_barrier
  s_cmp_lg_u32 s3, 0
  s_cbranch_scc1 LP_doneH
  s_mov_b32 s79, 0
LP_loopH:
  s_waitcnt vmcnt(0)
  v_cmp_ne_u32 vcc, 10, v90
  s_and_b32 s78, vcc_lo, 65535
  s_cbranch_scc0 LP_doneH
  s_mov_b64 exec, 65535
  v_mov_b32 v90, 0
  buffer_atomic_add v90, v91, s[36:39], 0 offen offset:4 sc0 sc1
  s_mov_b64 exec, -1
  s_add_u32 s79, s79, 1
  s_cmp_lt_u32 s79, 100000
  s_cbranch_scc1 LP_loopH
  s_waitcnt vmcnt(0)
LP_doneH:
  s_barrier
  ds_read_b128 v[16:19], v2 offset:8192
  ds_read_b128 v[20:23], v2 offset:12288
  ds_read_b128 v[24:27], v2 offset:9216
  buffer_load_dwordx4 v[96:99], v10, s[40:43], s65 offen sc1
  s_add_u32 s65, s65, 65536
  buffer_load_dwordx4 v[100:103], v10, s[40:43], s65 offen sc1
  s_add_u32 s65, s65, 65536
  buffer_load_dwordx4 v[104:107], v10, s[40:43], s65 offen sc1
  s_add_u32 s65, s65, 65536
  buffer_load_dwordx4 v[108:111], v10, s[40:43], s65 offen sc1
  s_add_u32 s65, s65, 65536
  buffer_load_dwordx4 v[112:115], v10, s[40:43], s65 offen sc1
  s_add_u32 s65, s65, 65536
  buffer_load_dwordx4 v[116:119], v10, s[40:43], s65 offen sc1
  s_add_u32 s65, s65, 65536
  buffer_load_dwordx4 v[120:123], v10, s[40:43], s65 offen sc1
  s_add_u32 s65, s65, 65536
  buffer_load_dwordx4 v[124:127], v10, s[40:43], s65 offen sc1
  s_add_u32 s65, s65, 65536
  buffer_load_dwordx4 v[128:131], v10, s[40:43], s65 offen sc1
  s_add_u32 s65, s65, 65536
  buffer_load_dwordx4 v[132:135], v10, s[40:43], s65 offen sc1
  s_add_u32 s65, s65, 65536
  s_sub_u32 s66, s65, 2621440
  s_min_u32 s65, s65, s66
  buffer_load_dwordx4 v[136:139], v10, s[40:43], s65 offen sc1
  s_add_u32 s65, s65, 65536
  buffer_load_dwordx4 v[140:143], v10, s[40:43], s65 offen sc1
  s_add_u32 s65, s65, 65536
  buffer_load_dwordx4 v[144:147], v10, s[40:43], s65 offen sc1
  s_add_u32 s65, s65, 65536
  buffer_load_dwordx4 v[148:151], v10, s[40:43], s65 offen sc1
  s_add_u32 s65, s65, 65536
  s_waitcnt vmcnt(13)
  v_permlane16_swap_b32 v96, v98
  v_permlane16_swap_b32 v97, v99
  s_waitcnt lgkmcnt(2)
  s_nop 0
  v_mfma_f32_32x32x16_bf16 v[32:47], v[16:19], v[96:99], 0
  ds_read_b128 v[28:31], v2 offset:13312
  s_waitcnt vmcnt(12)
  v_permlane16_swap_b32 v100, v102
  v_permlane16_swap_b32 v101, v103
  s_waitcnt lgkmcnt(2)
  v_mfma_f32_32x32x16_bf16 v[48:63], v[20:23], v[96:99], 0
  ds_read_b128 v[16:19], v2 offset:10240
  buffer_load_dwordx4 v[152:155], v10, s[40:43], s65 offen sc1
  s_add_u32 s65, s65, 65536
  s_waitcnt lgkmcnt(2)
  v_mfma_f32_32x32x16_bf16 v[32:47], v[24:27], v[100:103], v[32:47]
  ds_read_b128 v[20:23], v2 offset:14336
  s_waitcnt vmcnt(12)
  v_permlane16_swap_b32 v104, v106
  v_permlane16_swap_b32 v105, v107
  s_waitcnt lgkmcnt(2)
  v_mfma_f32_32x32x16_bf16 v[48:63], v[28:31], v[100:103], v[48:63]
  ds_read_b128 v[24:27], v2 offset:11264
  buffer_load_dwordx4 v[156:159], v10, s[40:43], s65 offen sc1
  s_add_u32 s65, s65, 65536
  s_waitcnt lgkmcnt(2)
  v_mfma_f32_32x32x16_bf16 v[32:47], v[16:19], v[104:107], v[32:47]
  ds_read_b128 v[28:31], v2 offset:15360
  s_waitcnt vmcnt(12)
  v_permlane16_swap_b32 v108, v110
  v_permlane16_swap_b32 v109, v111
  s_waitcnt lgkmcnt(2)
  v_mfma_f32_32x32x16_bf16 v[48:63], v[20:23], v[104:107], v[48:63]
  ds_read_b128 v[16:19], v2 offset:16384
  buffer_load_dwordx4 v[160:163], v10, s[40:43], s65 offen sc1
  s_add_u32 s65, s65, 65536
  s_waitcnt lgkmcnt(2)
  v_mfma_f32_32x32x16_bf16 v[32:47], v[24:27], v[108:111], v[32:47]
  ds_read_b128 v[20:23], v2 offset:20480
  s_waitcnt vmcnt(12)
  v_permlane16_swap_b32 v112, v114
  v_permlane16_swap_b32 v113, v115
  s_waitcnt lgkmcnt(2)
  v_mfma_f32_32x32x16_bf16 v[48:63], v[28:31], v[108:111], v[48:63]
  ds_read_b128 v[24:27], v2 offset:17408
  buffer_load_dwordx4 v[164:167], v10, s[40:43], s65 offen sc1
  s_add_u32 s65, s65, 65536
  v_mfma_f32_4x4x4_16b_bf16 v[80:83], v[96:97], v[96:97], 0
  v_mfma_f32_4x4x4_16b_bf16 v[84:87], v[88:89], v[96:97], 0
  v_mfma_f32_4x4x4_16b_bf16 v[80:83], v[98:99], v[98:99], v[80:83]
  v_mfma_f32_4x4x4_16b_bf16 v[84:87], v[88:89], v[98:99], v[84:87]
  v_mfma_f32_4x4x4_16b_bf16 v[80:83], v[100:101], v[100:101], v[80:83]
  v_mfma_f32_4x4x4_16b_bf16 v[84:87], v[88:89], v[100:101], v[84:87]
  v_mfma_f32_4x4x4_16b_bf16 v[80:83], v[102:103], v[102:103], v[80:83]
  v_mfma_f32_4x4x4_16b_bf16 v[84:87], v[88:89], v[102:103], v[84:87]
  v_mfma_f32_4x4x4_16b_bf16 v[80:83], v[104:105], v[104:105], v[80:83]
  v_mfma_f32_4x4x4_16b_bf16 v[84:87], v[88:89], v[104:105], v[84:87]
  v_mfma_f32_4x4x4_16b_bf16 v[80:83], v[106:107], v[106:107], v[80:83]
  v_mfma_f32_4x4x4_16b_bf16 v[84:87], v[88:89], v[106:107], v[84:87]
  v_mfma_f32_4x4x4_16b_bf16 v[80:83], v[108:109], v[108:109], v[80:83]
  v_mfma_f32_4x4x4_16b_bf16 v[84:87], v[88:89], v[108:109], v[84:87]
  v_mfma_f32_4x4x4_16b_bf16 v[80:83], v[110:111], v[110:111], v[80:83]
  v_mfma_f32_4x4x4_16b_bf16 v[84:87], v[88:89], v[110:111], v[84:87]
  s_waitcnt lgkmcnt(2)
  v_mfma_f32_32x32x16_bf16 v[32:47], v[16:19], v[112:115], v[32:47]
  ds_read_b128 v[28:31], v2 offset:21504
  s_waitcnt vmcnt(12)
  v_permlane16_swap_b32 v116, v118
  v_permlane16_swap_b32 v117, v119
  s_waitcnt lgkmcnt(2)
  v_mfma_f32_32x32x16_bf16 v[48:63], v[20:23], v[112:115], v[48:63]
  ds_read_b128 v[16:19], v2 offset:18432
  buffer_load_dwordx4 v[168:171], v10, s[40:43], s65 offen sc1
  s_add_u32 s65, s65, 65536
  s_waitcnt lgkmcnt(2)
  v_mfma_f32_32x32x16_bf16 v[32:47], v[24:27], v[116:119], v[32:47]
  ds_read_b128 v[20:23], v2 offset:22528
  s_waitcnt vmcnt(12)
  v_permlane16_swap_b32 v120, v122
  v_permlane16_swap_b32 v121, v123
  s_waitcnt lgkmcnt(2)
  v_mfma_f32_32x32x16_bf16 v[48:63], v[28:31], v[116:119], v[48:63]
  ds_read_b128 v[24:27], v2 offset:19456
  buffer_load_dwordx4 v[172:175], v10, s[40:43], s65 offen sc1
  s_add_u32 s65, s65, 65536
  s_sub_u32 s66, s65, 2621440
  s_min_u32 s65, s65, s66
  s_waitcnt lgkmcnt(2)
  v_mfma_f32_32x32x16_bf16 v[32:47], v[16:19], v[120:123], v[32:47]
  ds_read_b128 v[28:31], v2 offset:23552
  s_waitcnt vmcnt(12)
  v_permlane16_swap_b32 v124, v126
  v_permlane16_swap_b32 v125, v127
  s_waitcnt lgkmcnt(2)
  v_mfma_f32_32x32x16_bf16 v[48:63], v[20:23], v[120:123], v[48:63]
  ds_read_b128 v[16:19], v2 offset:24576
  buffer_load_dwordx4 v[176:179], v10, s[40:43], s65 offen sc1
  s_add_u32 s65, s65, 65536
  s_waitcnt lgkmcnt(2)
  v_mfma_f32_32x32x16_bf16 v[32:47], v[24:27], v[124:127], v[32:47]
  ds_read_b128 v[20:23], v2 offset:28672
  s_waitcnt vmcnt(12)
  v_permlane16_swap_b32 v128, v130
  v_permlane16_swap_b32 v129, v131
  s_waitcnt lgkmcnt(2)
  v_mfma_f32_32x32x16_bf16 v[48:63], v[28:31], v[124:127], v[48:63]
  ds_read_b128 v[24:27], v2 offset:25600
  buffer_load_dwordx4 v[180:183], v10, s[40:43], s65 offen sc1
  s_add_u32 s65, s65, 65536
  v_mfma_f32_4x4x4_16b_bf16 v[80:83], v[112:113], v[112:113], v[80:83]
  v_mfma_f32_4x4x4_16b_bf16 v[84:87], v[88:89], v[112:113], v[84:87]
  v_mfma_f32_4x4x4_16b_bf16 v[80:83], v[114:115], v[114:115], v[80:83]
  v_mfma_f32_4x4x4_16b_bf16 v[84:87], v[88:89], v[114:115], v[84:87]
  v_mfma_f32_4x4x4_16b_bf16 v[80:83], v[116:117], v[116:117], v[80:83]
  v_mfma_f32_4x4x4_16b_bf16 v[84:87], v[88:89], v[116:117], v[84:87]
  v_mfma_f32_4x4x4_16b_bf16 v[80:83], v[118:119], v[118:119], v[80:83]
  v_mfma_f32_4x4x4_16b_bf16 v[84:87], v[88:89], v[118:119], v[84:87]
  v_mfma_f32_4x4x4_16b_bf16 v[80:83], v[120:121], v[120:121], v[80:83]
  v_mfma_f32_4x4x4_16b_bf16 v[84:87], v[88:89], v[120:121], v[84:87]
  v_mfma_f32_4x4x4_16b_bf16 v[80:83], v[122:123], v[122:123], v[80:83]
  v_mfma_f32_4x4x4_16b_bf16 v[84:87], v[88:89], v[122:123], v[84:87]
  v_mfma_f32_4x4x4_16b_bf16 v[80:83], v[124:125], v[124:125], v[80:83]
  v_mfma_f32_4x4x4_16b_bf16 v[84:87], v[88:89], v[124:125], v[84:87]
  v_mfma_f32_4x4x4_16b_bf16 v[80:83], v[126:127], v[126:127], v[80:83]
  v_mfma_f32_4x4x4_16b_bf16 v[84:87], v[88:89], v[126:127], v[84:87]
  s_waitcnt lgkmcnt(2)
  v_mfma_f32_32x32x16_bf16 v[32:47], v[16:19], v[128:131], v[32:47]
  ds_read_b128 v[28:31], v2 offset:29696
  s_waitcnt vmcnt(12)
  v_permlane16_swap_b32 v132, v134
  v_permlane16_swap_b32 v133, v135
  s_waitcnt lgkmcnt(2)
  v_mfma_f32_32x32x16_bf16 v[48:63], v[20:23], v[128:131], v[48:63]
  ds_read_b128 v[16:19], v2 offset:26624
  buffer_load_dwordx4 v[184:187], v10, s[40:43], s65 offen sc1
  s_add_u32 s65, s65, 65536
  s_waitcnt lgkmcnt(2)
  v_mfma_f32_32x32x16_bf16 v[32:47], v[24:27], v[132:135], v[32:47]
  ds_read_b128 v[20:23], v2 offset:30720
  s_waitcnt vmcnt(12)
  v_permlane16_swap_b32 v136, v138
  v_permlane16_swap_b32 v137, v139
  s_waitcnt lgkmcnt(2)
  v_mfma_f32_32x32x16_bf16 v[48:63], v[28:31], v[132:135], v[48:63]
  ds_read_b128 v[24:27], v2 offset:27648
  buffer_load_dwordx4 v[188:191], v10, s[40:43], s65 offen sc1
  s_add_u32 s65, s65, 65536
  s_waitcnt lgkmcnt(2)
  v_mfma_f32_32x32x16_bf16 v[32:47], v[16:19], v[136:139], v[32:47]
  ds_read_b128 v[28:31], v2 offset:31744
  s_waitcnt vmcnt(12)
  v_permlane16_swap_b32 v140, v142
  v_permlane16_swap_b32 v141, v143
  s_waitcnt lgkmcnt(2)
  v_mfma_f32_32x32x16_bf16 v[48:63], v[20:23], v[136:139], v[48:63]
  ds_read_b128 v[16:19], v2 offset:32768
  buffer_load_dwordx4 v[192:195], v10, s[40:43], s65 offen sc1
  s_add_u32 s65, s65, 65536
  s_waitcnt lgkmcnt(2)
  v_mfma_f32_32x32x16_bf16 v[32:47], v[24:27], v[140:143], v[32:47]
  ds_read_b128 v[20:23], v2 offset:36864
  s_waitcnt vmcnt(12)
  v_permlane16_swap_b32 v144, v146
  v_permlane16_swap_b32 v145, v147
  s_waitcnt lgkmcnt(2)
  v_mfma_f32_32x32x16_bf16 v[48:63], v[28:31], v[140:143], v[48:63]
  ds_read_b128 v[24:27], v2 offset:33792
  buffer_load_dwordx4 v[196:199], v10, s[40:43], s65 offen sc1
  s_add_u32 s65, s65, 65536
  v_mfma_f32_4x4x4_16b_bf16 v[80:83], v[128:129], v[128:129], v[80:83]
  v_mfma_f32_4x4x4_16b_bf16 v[84:87], v[88:89], v[128:129], v[84:87]
  v_mfma_f32_4x4x4_16b_bf16 v[80:83], v[130:131], v[130:131], v[80:83]
  v_mfma_f32_4x4x4_16b_bf16 v[84:87], v[88:89], v[130:131], v[84:87]
  v_mfma_f32_4x4x4_16b_bf16 v[80:83], v[132:133], v[132:133], v[80:83]
  v_mfma_f32_4x4x4_16b_bf16 v[84:87], v[88:89], v[132:133], v[84:87]
  v_mfma_f32_4x4x4_16b_bf16 v[80:83], v[134:135], v[134:135], v[80:83]
  v_mfma_f32_4x4x4_16b_bf16 v[84:87], v[88:89], v[134:135], v[84:87]
  v_mfma_f32_4x4x4_16b_bf16 v[80:83], v[136:137], v[136:137], v[80:83]
  v_mfma_f32_4x4x4_16b_bf16 v[84:87], v[88:89], v[136:137], v[84:87]
  v_mfma_f32_4x4x4_16b_bf16 v[80:83], v[138:139], v[138:139], v[80:83]
  v_mfma_f32_4x4x4_16b_bf16 v[84:87], v[88:89], v[138:139], v[84:87]
  v_mfma_f32_4x4x4_16b_bf16 v[80:83], v[140:141], v[140:141], v[80:83]
  v_mfma_f32_4x4x4_16b_bf16 v[84:87], v[88:89], v[140:141], v[84:87]
  v_mfma_f32_4x4x4_16b_bf16 v[80:83], v[142:143], v[142:143], v[80:83]
  v_mfma_f32_4x4x4_16b_bf16 v[84:87], v[88:89], v[142:143], v[84:87]
  s_waitcnt lgkmcnt(2)
  v_mfma_f32_32x32x16_bf16 v[32:47], v[16:19], v[144:147], v[32:47]
  ds_read_b128 v[28:31], v2 offset:37888
  s_waitcnt vmcnt(12)
  v_permlane16_swap_b32 v148, v150
  v_permlane16_swap_b32 v149, v151
  s_waitcnt lgkmcnt(2)
  v_mfma_f32_32x32x16_bf16 v[48:63], v[20:23], v[144:147], v[48:63]
  ds_read_b128 v[16:19], v2 offset:34816
  buffer_load_dwordx4 v[200:203], v10, s[40:43], s65 offen sc1
  s_add_u32 s65, s65, 65536
  s_waitcnt lgkmcnt(2)
  v_mfma_f32_32x32x16_bf16 v[32:47], v[24:27], v[148:151], v[32:47]
  ds_read_b128 v[20:23], v2 offset:38912
  s_waitcnt vmcnt(12)
  v_permlane16_swap_b32 v152, v154
  v_permlane16_swap_b32 v153, v155
  s_waitcnt lgkmcnt(2)
  v_mfma_f32_32x32x16_bf16 v[48:63], v[28:31], v[148:151], v[48:63]
  ds_read_b128 v[24:27], v2 offset:35840
  buffer_load_dwordx4 v[204:207], v10, s[40:43], s65 offen sc1
  s_add_u32 s65, s65, 65536
  s_waitcnt lgkmcnt(2)
  v_mfma_f32_32x32x16_bf16 v[32:47], v[16:19], v[152:155], v[32:47]
  ds_read_b128 v[28:31], v2 offset:39936
  s_waitcnt vmcnt(12)
  v_permlane16_swap_b32 v156, v158
  v_permlane16_swap_b32 v157, v159
  s_waitcnt lgkmcnt(2)
  v_mfma_f32_32x32x16_bf16 v[48:63], v[20:23], v[152:155], v[48:63]
  ds_read_b128 v[16:19], v2 offset:40960
  buffer_load_dwordx4 v[208:211], v10, s[40:43], s65 offen sc1
  s_add_u32 s65, s65, 65536
  s_waitcnt lgkmcnt(2)
  v_mfma_f32_32x32x16_bf16 v[32:47], v[24:27], v[156:159], v[32:47]
  ds_read_b128 v[20:23], v2 offset:45056
  s_waitcnt vmcnt(12)
  v_permlane16_swap_b32 v160, v162
  v_permlane16_swap_b32 v161, v163
  s_waitcnt lgkmcnt(2)
  v_mfma_f32_32x32x16_bf16 v[48:63], v[28:31], v[156:159], v[48:63]
  ds_read_b128 v[24:27], v2 offset:41984
  buffer_load_dwordx4 v[212:215], v10, s[40:43], s65 offen sc1
  s_add_u32 s65, s65, 65536
  s_sub_u32 s66, s65, 2621440
  s_min_u32 s65, s65, s66
  v_mfma_f32_4x4x4_16b_bf16 v[80:83], v[144:145], v[144:145], v[80:83]
  v_mfma_f32_4x4x4_16b_bf16 v[84:87], v[88:89], v[144:145], v[84:87]
  v_mfma_f32_4x4x4_16b_bf16 v[80:83], v[146:147], v[146:147], v[80:83]
  v_mfma_f32_4x4x4_16b_bf16 v[84:87], v[88:89], v[146:147], v[84:87]
  v_mfma_f32_4x4x4_16b_bf16 v[80:83], v[148:149], v[148:149], v[80:83]
  v_mfma_f32_4x4x4_16b_bf16 v[84:87], v[88:89], v[148:149], v[84:87]
  v_mfma_f32_4x4x4_16b_bf16 v[80:83], v[150:151], v[150:151], v[80:83]
  v_mfma_f32_4x4x4_16b_bf16 v[84:87], v[88:89], v[150:151], v[84:87]
  v_mfma_f32_4x4x4_16b_bf16 v[80:83], v[152:153], v[152:153], v[80:83]
  v_mfma_f32_4x4x4_16b_bf16 v[84:87], v[88:89], v[152:153], v[84:87]
  v_mfma_f32_4x4x4_16b_bf16 v[80:83], v[154:155], v[154:155], v[80:83]
  v_mfma_f32_4x4x4_16b_bf16 v[84:87], v[88:89], v[154:155], v[84:87]
  v_mfma_f32_4x4x4_16b_bf16 v[80:83], v[156:157], v[156:157], v[80:83]
  v_mfma_f32_4x4x4_16b_bf16 v[84:87], v[88:89], v[156:157], v[84:87]
  v_mfma_f32_4x4x4_16b_bf16 v[80:83], v[158:159], v[158:159], v[80:83]
  v_mfma_f32_4x4x4_16b_bf16 v[84:87], v[88:89], v[158:159], v[84:87]
  s_waitcnt lgkmcnt(2)
  v_mfma_f32_32x32x16_bf16 v[32:47], v[16:19], v[160:163], v[32:47]
  ds_read_b128 v[28:31], v2 offset:46080
  s_waitcnt vmcnt(12)
  v_permlane16_swap_b32 v164, v166
  v_permlane16_swap_b32 v165, v167
  s_waitcnt lgkmcnt(2)
  v_mfma_f32_32x32x16_bf16 v[48:63], v[20:23], v[160:163], v[48:63]
  ds_read_b128 v[16:19], v2 offset:43008
  buffer_load_dwordx4 v[216:219], v10, s[40:43], s65 offen sc1
  s_add_u32 s65, s65, 65536
  s_waitcnt lgkmcnt(2)
  v_mfma_f32_32x32x16_bf16 v[32:47], v[24:27], v[164:167], v[32:47]
  ds_read_b128 v[20:23], v2 offset:47104
  s_waitcnt vmcnt(12)
  v_permlane16_swap_b32 v168, v170
  v_permlane16_swap_b32 v169, v171
  s_waitcnt lgkmcnt(2)
  v_mfma_f32_32x32x16_bf16 v[48:63], v[28:31], v[164:167], v[48:63]
  ds_read_b128 v[24:27], v2 offset:44032
  buffer_load_dwordx4 v[220:223], v10, s[40:43], s65 offen sc1
  s_add_u32 s65, s65, 65536
  s_waitcnt lgkmcnt(2)
  v_mfma_f32_32x32x16_bf16 v[32:47], v[16:19], v[168:171], v[32:47]
  ds_read_b128 v[28:31], v2 offset:48128
  s_waitcnt vmcnt(12)
  v_permlane16_swap_b32 v172, v174
  v_permlane16_swap_b32 v173, v175
  s_waitcnt lgkmcnt(2)
  v_mfma_f32_32x32x16_bf16 v[48:63], v[20:23], v[168:171], v[48:63]
  ds_read_b128 v[16:19], v2 offset:49152
  buffer_load_dwordx4 v[224:227], v10, s[40:43], s65 offen sc1
  s_add_u32 s65, s65, 65536
  s_waitcnt lgkmcnt(2)
  v_mfma_f32_32x32x16_bf16 v[32:47], v[24:27], v[172:175], v[32:47]
  ds_read_b128 v[20:23], v2 offset:53248
  s_waitcnt vmcnt(12)
  v_permlane16_swap_b32 v176, v178
  v_permlane16_swap_b32 v177, v179
  s_waitcnt lgkmcnt(2)
  v_mfma_f32_32x32x16_bf16 v[48:63], v[28:31], v[172:175], v[48:63]
  ds_read_b128 v[24:27], v2 offset:50176
  buffer_load_dwordx4 v[228:231], v10, s[40:43], s65 offen sc1
  s_add_u32 s65, s65, 65536
  v_mfma_f32_4x4x4_16b_bf16 v[80:83], v[160:161], v[160:161], v[80:83]
  v_mfma_f32_4x4x4_16b_bf16 v[84:87], v[88:89], v[160:161], v[84:87]
  v_mfma_f32_4x4x4_16b_bf16 v[80:83], v[162:163], v[162:163], v[80:83]
  v_mfma_f32_4x4x4_16b_bf16 v[84:87], v[88:89], v[162:163], v[84:87]
  v_mfma_f32_4x4x4_16b_bf16 v[80:83], v[164:165], v[164:165], v[80:83]
  v_mfma_f32_4x4x4_16b_bf16 v[84:87], v[88:89], v[164:165], v[84:87]
  v_mfma_f32_4x4x4_16b_bf16 v[80:83], v[166:167], v[166:167], v[80:83]
  v_mfma_f32_4x4x4_16b_bf16 v[84:87], v[88:89], v[166:167], v[84:87]
  v_mfma_f32_4x4x4_16b_bf16 v[80:83], v[168:169], v[168:169], v[80:83]
  v_mfma_f32_4x4x4_16b_bf16 v[84:87], v[88:89], v[168:169], v[84:87]
  v_mfma_f32_4x4x4_16b_bf16 v[80:83], v[170:171], v[170:171], v[80:83]
  v_mfma_f32_4x4x4_16b_bf16 v[84:87], v[88:89], v[170:171], v[84:87]
  v_mfma_f32_4x4x4_16b_bf16 v[80:83], v[172:173], v[172:173], v[80:83]
  v_mfma_f32_4x4x4_16b_bf16 v[84:87], v[88:89], v[172:173], v[84:87]
  v_mfma_f32_4x4x4_16b_bf16 v[80:83], v[174:175], v[174:175], v[80:83]
  v_mfma_f32_4x4x4_16b_bf16 v[84:87], v[88:89], v[174:175], v[84:87]
  s_waitcnt lgkmcnt(2)
  v_mfma_f32_32x32x16_bf16 v[32:47], v[16:19], v[176:179], v[32:47]
  ds_read_b128 v[28:31], v2 offset:54272
  s_waitcnt vmcnt(12)
  v_permlane16_swap_b32 v180, v182
  v_permlane16_swap_b32 v181, v183
  s_waitcnt lgkmcnt(2)
  v_mfma_f32_32x32x16_bf16 v[48:63], v[20:23], v[176:179], v[48:63]
  ds_read_b128 v[16:19], v2 offset:51200
  buffer_load_dwordx4 v[232:235], v10, s[40:43], s65 offen sc1
  s_add_u32 s65, s65, 65536
  s_waitcnt lgkmcnt(2)
  v_mfma_f32_32x32x16_bf16 v[32:47], v[24:27], v[180:183], v[32:47]
  ds_read_b128 v[20:23], v2 offset:55296
  s_waitcnt vmcnt(12)
  v_permlane16_swap_b32 v184, v186
  v_permlane16_swap_b32 v185, v187
  s_waitcnt lgkmcnt(2)
  v_mfma_f32_32x32x16_bf16 v[48:63], v[28:31], v[180:183], v[48:63]
  ds_read_b128 v[24:27], v2 offset:52224
  buffer_load_dwordx4 v[236:239], v10, s[40:43], s65 offen sc1
  s_add_u32 s65, s65, 65536
  s_waitcnt lgkmcnt(2)
  v_mfma_f32_32x32x16_bf16 v[32:47], v[16:19], v[184:187], v[32:47]
  ds_read_b128 v[28:31], v2 offset:56320
  s_waitcnt vmcnt(12)
  v_permlane16_swap_b32 v188, v190
  v_permlane16_swap_b32 v189, v191
  s_waitcnt lgkmcnt(2)
  v_mfma_f32_32x32x16_bf16 v[48:63], v[20:23], v[184:187], v[48:63]
  s_barrier
  ds_read_b128 v[16:19], v2 offset:57344
  buffer_load_dwordx4 v[240:243], v10, s[40:43], s65 offen sc1
  s_add_u32 s65, s65, 65536
  s_waitcnt lgkmcnt(2)
  v_mfma_f32_32x32x16_bf16 v[32:47], v[24:27], v[188:191], v[32:47]
  ds_read_b128 v[20:23], v2 offset:61440
  s_waitcnt vmcnt(12)
  v_permlane16_swap_b32 v192, v194
  v_permlane16_swap_b32 v193, v195
  s_waitcnt lgkmcnt(2)
  v_mfma_f32_32x32x16_bf16 v[48:63], v[28:31], v[188:191], v[48:63]
  ds_read_b128 v[24:27], v2 offset:58368
  buffer_load_dwordx4 v[244:247], v10, s[40:43], s65 offen sc1
  s_add_u32 s65, s65, 65536
  v_mfma_f32_4x4x4_16b_bf16 v[80:83], v[176:177], v[176:177], v[80:83]
  v_mfma_f32_4x4x4_16b_bf16 v[84:87], v[88:89], v[176:177], v[84:87]
  v_mfma_f32_4x4x4_16b_bf16 v[80:83], v[178:179], v[178:179], v[80:83]
  v_mfma_f32_4x4x4_16b_bf16 v[84:87], v[88:89], v[178:179], v[84:87]
  v_mfma_f32_4x4x4_16b_bf16 v[80:83], v[180:181], v[180:181], v[80:83]
  v_mfma_f32_4x4x4_16b_bf16 v[84:87], v[88:89], v[180:181], v[84:87]
  v_mfma_f32_4x4x4_16b_bf16 v[80:83], v[182:183], v[182:183], v[80:83]
  v_mfma_f32_4x4x4_16b_bf16 v[84:87], v[88:89], v[182:183], v[84:87]
  v_mfma_f32_4x4x4_16b_bf16 v[80:83], v[184:185], v[184:185], v[80:83]
  v_mfma_f32_4x4x4_16b_bf16 v[84:87], v[88:89], v[184:185], v[84:87]
  v_mfma_f32_4x4x4_16b_bf16 v[80:83], v[186:187], v[186:187], v[80:83]
  v_mfma_f32_4x4x4_16b_bf16 v[84:87], v[88:89], v[186:187], v[84:87]
  v_mfma_f32_4x4x4_16b_bf16 v[80:83], v[188:189], v[188:189], v[80:83]
  v_mfma_f32_4x4x4_16b_bf16 v[84:87], v[88:89], v[188:189], v[84:87]
  v_mfma_f32_4x4x4_16b_bf16 v[80:83], v[190:191], v[190:191], v[80:83]
  v_mfma_f32_4x4x4_16b_bf16 v[84:87], v[88:89], v[190:191], v[84:87]
  s_waitcnt lgkmcnt(2)
  v_mfma_f32_32x32x16_bf16 v[32:47], v[16:19], v[192:195], v[32:47]
  ds_read_b128 v[28:31], v2 offset:62464
  s_waitcnt vmcnt(12)
  v_permlane16_swap_b32 v196, v198
  v_permlane16_swap_b32 v197, v199
  s_waitcnt lgkmcnt(2)
  v_mfma_f32_32x32x16_bf16 v[48:63], v[20:23], v[192:195], v[48:63]
  ds_read_b128 v[16:19], v2 offset:59392
  buffer_load_dwordx4 v[248:251], v10, s[40:43], s65 offen sc1
  s_add_u32 s65, s65, 65536
  s_waitcnt lgkmcnt(2)
  v_mfma_f32_32x32x16_bf16 v[32:47], v[24:27], v[196:199], v[32:47]
  ds_read_b128 v[20:23], v2 offset:63488
  s_waitcnt vmcnt(12)
  v_permlane16_swap_b32 v200, v202
  v_permlane16_swap_b32 v201, v203
  s_waitcnt lgkmcnt(2)
  v_mfma_f32_32x32x16_bf16 v[48:63], v[28:31], v[196:199], v[48:63]
  ds_read_b128 v[24:27], v2 offset:60416
  buffer_load_dwordx4 v[252:255], v10, s[40:43], s65 offen sc1
  s_waitcnt lgkmcnt(2)
  v_mfma_f32_32x32x16_bf16 v[32:47], v[16:19], v[200:203], v[32:47]
  ds_read_b128 v[28:31], v2 offset:64512
  s_waitcnt vmcnt(12)
  v_permlane16_swap_b32 v204, v206
  v_permlane16_swap_b32 v205, v207
  s_waitcnt lgkmcnt(2)
  v_mfma_f32_32x32x16_bf16 v[48:63], v[20:23], v[200:203], v[48:63]
  ds_read_b128 v[16:19], v4 offset:0
  s_waitcnt lgkmcnt(2)
  v_mfma_f32_32x32x16_bf16 v[32:47], v[24:27], v[204:207], v[32:47]
  ds_read_b128 v[20:23], v4 offset:4096
  s_waitcnt vmcnt(11)
  v_permlane16_swap_b32 v208, v210
  v_permlane16_swap_b32 v209, v211
  s_waitcnt lgkmcnt(2)
  v_mfma_f32_32x32x16_bf16 v[48:63], v[28:31], v[204:207], v[48:63]
  ds_read_b128 v[24:27], v4 offset:1024
  v_mfma_f32_4x4x4_16b_bf16 v[80:83], v[192:193], v[192:193], v[80:83]
  v_mfma_f32_4x4x4_16b_bf16 v[84:87], v[88:89], v[192:193], v[84:87]
  v_mfma_f32_4x4x4_16b_bf16 v[80:83], v[194:195], v[194:195], v[80:83]
  v_mfma_f32_4x4x4_16b_bf16 v[84:87], v[88:89], v[194:195], v[84:87]
  v_mfma_f32_4x4x4_16b_bf16 v[80:83], v[196:197], v[196:197], v[80:83]
  v_mfma_f32_4x4x4_16b_bf16 v[84:87], v[88:89], v[196:197], v[84:87]
  v_mfma_f32_4x4x4_16b_bf16 v[80:83], v[198:199], v[198:199], v[80:83]
  v_mfma_f32_4x4x4_16b_bf16 v[84:87], v[88:89], v[198:199], v[84:87]
  v_mfma_f32_4x4x4_16b_bf16 v[80:83], v[200:201], v[200:201], v[80:83]
  v_mfma_f32_4x4x4_16b_bf16 v[84:87], v[88:89], v[200:201], v[84:87]
  v_mfma_f32_4x4x4_16b_bf16 v[80:83], v[202:203], v[202:203], v[80:83]
  v_mfma_f32_4x4x4_16b_bf16 v[84:87], v[88:89], v[202:203], v[84:87]
  v_mfma_f32_4x4x4_16b_bf16 v[80:83], v[204:205], v[204:205], v[80:83]
  v_mfma_f32_4x4x4_16b_bf16 v[84:87], v[88:89], v[204:205], v[84:87]
  v_mfma_f32_4x4x4_16b_bf16 v[80:83], v[206:207], v[206:207], v[80:83]
  v_mfma_f32_4x4x4_16b_bf16 v[84:87], v[88:89], v[206:207], v[84:87]
  s_waitcnt lgkmcnt(2)
  v_mfma_f32_32x32x16_bf16 v[32:47], v[16:19], v[208:211], v[32:47]
  ds_read_b128 v[28:31], v4 offset:5120
  s_waitcnt vmcnt(10)
  v_permlane16_swap_b32 v212, v214
  v_permlane16_swap_b32 v213, v215
  s_waitcnt lgkmcnt(2)
  v_mfma_f32_32x32x16_bf16 v[48:63], v[20:23], v[208:211], v[48:63]
  ds_read_b128 v[16:19], v4 offset:2048
  s_waitcnt lgkmcnt(2)
  v_mfma_f32_32x32x16_bf16 v[32:47], v[24:27], v[212:215], v[32:47]
  ds_read_b128 v[20:23], v4 offset:6144
  s_waitcnt vmcnt(9)
  v_permlane16_swap_b32 v216, v218
  v_permlane16_swap_b32 v217, v219
  s_waitcnt lgkmcnt(2)
  v_mfma_f32_32x32x16_bf16 v[48:63], v[28:31], v[212:215], v[48:63]
  ds_read_b128 v[24:27], v4 offset:3072
  s_waitcnt lgkmcnt(2)
  v_mfma_f32_32x32x16_bf16 v[32:47], v[16:19], v[216:219], v[32:47]
  ds_read_b128 v[28:31], v4 offset:7168
  s_waitcnt vmcnt(8)
  v_permlane16_swap_b32 v220, v222
  v_permlane16_swap_b32 v221, v223
  s_waitcnt lgkmcnt(2)
  v_mfma_f32_32x32x16_bf16 v[48:63], v[20:23], v[216:219], v[48:63]
  ds_read_b128 v[16:19], v4 offset:8192
  s_waitcnt lgkmcnt(2)
  v_mfma_f32_32x32x16_bf16 v[32:47], v[24:27], v[220:223], v[32:47]
  ds_read_b128 v[20:23], v4 offset:12288
  s_waitcnt vmcnt(7)
  v_permlane16_swap_b32 v224, v226
  v_permlane16_swap_b32 v225, v227
  s_waitcnt lgkmcnt(2)
  v_mfma_f32_32x32x16_bf16 v[48:63], v[28:31], v[220:223], v[48:63]
  ds_read_b128 v[24:27], v4 offset:9216
  v_mfma_f32_4x4x4_16b_bf16 v[80:83], v[208:209], v[208:209], v[80:83]
  v_mfma_f32_4x4x4_16b_bf16 v[84:87], v[88:89], v[208:209], v[84:87]
  v_mfma_f32_4x4x4_16b_bf16 v[80:83], v[210:211], v[210:211], v[80:83]
  v_mfma_f32_4x4x4_16b_bf16 v[84:87], v[88:89], v[210:211], v[84:87]
  v_mfma_f32_4x4x4_16b_bf16 v[80:83], v[212:213], v[212:213], v[80:83]
  v_mfma_f32_4x4x4_16b_bf16 v[84:87], v[88:89], v[212:213], v[84:87]
  v_mfma_f32_4x4x4_16b_bf16 v[80:83], v[214:215], v[214:215], v[80:83]
  v_mfma_f32_4x4x4_16b_bf16 v[84:87], v[88:89], v[214:215], v[84:87]
  v_mfma_f32_4x4x4_16b_bf16 v[80:83], v[216:217], v[216:217], v[80:83]
  v_mfma_f32_4x4x4_16b_bf16 v[84:87], v[88:89], v[216:217], v[84:87]
  v_mfma_f32_4x4x4_16b_bf16 v[80:83], v[218:219], v[218:219], v[80:83]
  v_mfma_f32_4x4x4_16b_bf16 v[84:87], v[88:89], v[218:219], v[84:87]
  v_mfma_f32_4x4x4_16b_bf16 v[80:83], v[220:221], v[220:221], v[80:83]
  v_mfma_f32_4x4x4_16b_bf16 v[84:87], v[88:89], v[220:221], v[84:87]
  v_mfma_f32_4x4x4_16b_bf16 v[80:83], v[222:223], v[222:223], v[80:83]
  v_mfma_f32_4x4x4_16b_bf16 v[84:87], v[88:89], v[222:223], v[84:87]
  s_waitcnt lgkmcnt(2)
  v_mfma_f32_32x32x16_bf16 v[32:47], v[16:19], v[224:227], v[32:47]
  ds_read_b128 v[28:31], v4 offset:13312
  s_waitcnt vmcnt(6)
  v_permlane16_swap_b32 v228, v230
  v_permlane16_swap_b32 v229, v231
  s_waitcnt lgkmcnt(2)
  v_mfma_f32_32x32x16_bf16 v[48:63], v[20:23], v[224:227], v[48:63]
  ds_read_b128 v[16:19], v4 offset:10240
  s_waitcnt lgkmcnt(2)
  v_mfma_f32_32x32x16_bf16 v[32:47], v[24:27], v[228:231], v[32:47]
  ds_read_b128 v[20:23], v4 offset:14336
  s_waitcnt vmcnt(5)
  v_permlane16_swap_b32 v232, v234
  v_permlane16_swap_b32 v233, v235
  s_waitcnt lgkmcnt(2)
  v_mfma_f32_32x32x16_bf16 v[48:63], v[28:31], v[228:231], v[48:63]
  ds_read_b128 v[24:27], v4 offset:11264
  s_waitcnt lgkmcnt(2)
  v_mfma_f32_32x32x16_bf16 v[32:47], v[16:19], v[232:235], v[32:47]
  ds_read_b128 v[28:31], v4 offset:15360
  s_waitcnt vmcnt(4)
  v_permlane16_swap_b32 v236, v238
  v_permlane16_swap_b32 v237, v239
  s_waitcnt lgkmcnt(2)
  v_mfma_f32_32x32x16_bf16 v[48:63], v[20:23], v[232:235], v[48:63]
  ds_read_b128 v[16:19], v4 offset:16384
  s_waitcnt lgkmcnt(2)
  v_mfma_f32_32x32x16_bf16 v[32:47], v[24:27], v[236:239], v[32:47]
  ds_read_b128 v[20:23], v4 offset:20480
  s_waitcnt vmcnt(3)
  v_permlane16_swap_b32 v240, v242
  v_permlane16_swap_b32 v241, v243
  s_waitcnt lgkmcnt(2)
  v_mfma_f32_32x32x16_bf16 v[48:63], v[28:31], v[236:239], v[48:63]
  ds_read_b128 v[24:27], v4 offset:17408
  v_mfma_f32_4x4x4_16b_bf16 v[80:83], v[224:225], v[224:225], v[80:83]
  v_mfma_f32_4x4x4_16b_bf16 v[84:87], v[88:89], v[224:225], v[84:87]
  v_mfma_f32_4x4x4_16b_bf16 v[80:83], v[226:227], v[226:227], v[80:83]
  v_mfma_f32_4x4x4_16b_bf16 v[84:87], v[88:89], v[226:227], v[84:87]
  v_mfma_f32_4x4x4_16b_bf16 v[80:83], v[228:229], v[228:229], v[80:83]
  v_mfma_f32_4x4x4_16b_bf16 v[84:87], v[88:89], v[228:229], v[84:87]
  v_mfma_f32_4x4x4_16b_bf16 v[80:83], v[230:231], v[230:231], v[80:83]
  v_mfma_f32_4x4x4_16b_bf16 v[84:87], v[88:89], v[230:231], v[84:87]
  v_mfma_f32_4x4x4_16b_bf16 v[80:83], v[232:233], v[232:233], v[80:83]
  v_mfma_f32_4x4x4_16b_bf16 v[84:87], v[88:89], v[232:233], v[84:87]
  v_mfma_f32_4x4x4_16b_bf16 v[80:83], v[234:235], v[234:235], v[80:83]
  v_mfma_f32_4x4x4_16b_bf16 v[84:87], v[88:89], v[234:235], v[84:87]
  v_mfma_f32_4x4x4_16b_bf16 v[80:83], v[236:237], v[236:237], v[80:83]
  v_mfma_f32_4x4x4_16b_bf16 v[84:87], v[88:89], v[236:237], v[84:87]
  v_mfma_f32_4x4x4_16b_bf16 v[80:83], v[238:239], v[238:239], v[80:83]
  v_mfma_f32_4x4x4_16b_bf16 v[84:87], v[88:89], v[238:239], v[84:87]
  s_waitcnt lgkmcnt(2)
  v_mfma_f32_32x32x16_bf16 v[32:47], v[16:19], v[240:243], v[32:47]
  ds_read_b128 v[28:31], v4 offset:21504
  s_waitcnt vmcnt(2)
  v_permlane16_swap_b32 v244, v246
  v_permlane16_swap_b32 v245, v247
  s_waitcnt lgkmcnt(2)
  v_mfma_f32_32x32x16_bf16 v[48:63], v[20:23], v[240:243], v[48:63]
  ds_read_b128 v[16:19], v4 offset:18432
  s_waitcnt lgkmcnt(2)
  v_mfma_f32_32x32x16_bf16 v[32:47], v[24:27], v[244:247], v[32:47]
  ds_read_b128 v[20:23], v4 offset:22528
  s_waitcnt vmcnt(1)
  v_permlane16_swap_b32 v248, v250
  v_permlane16_swap_b32 v249, v251
  s_waitcnt lgkmcnt(2)
  v_mfma_f32_32x32x16_bf16 v[48:63], v[28:31], v[244:247], v[48:63]
  ds_read_b128 v[24:27], v4 offset:19456
  s_waitcnt lgkmcnt(2)
  v_mfma_f32_32x32x16_bf16 v[32:47], v[16:19], v[248:251], v[32:47]
  ds_read_b128 v[28:31], v4 offset:23552
  s_waitcnt vmcnt(0)
  v_permlane16_swap_b32 v252, v254
  v_permlane16_swap_b32 v253, v255
  s_waitcnt lgkmcnt(2)
  v_mfma_f32_32x32x16_bf16 v[48:63], v[20:23], v[248:251], v[48:63]
  s_barrier
  ds_read_b128 v[16:19], v4 offset:24576
  s_waitcnt lgkmcnt(2)
  v_mfma_f32_32x32x16_bf16 v[32:47], v[24:27], v[252:255], v[32:47]
  ds_read_b128 v[20:23], v4 offset:25600
  s_waitcnt lgkmcnt(2)
  v_mfma_f32_32x32x16_bf16 v[48:63], v[28:31], v[252:255], v[48:63]
  ds_read_b128 v[24:27], v4 offset:26624
  v_mfma_f32_4x4x4_16b_bf16 v[80:83], v[240:241], v[240:241], v[80:83]
  v_mfma_f32_4x4x4_16b_bf16 v[84:87], v[88:89], v[240:241], v[84:87]
  v_mfma_f32_4x4x4_16b_bf16 v[80:83], v[242:243], v[242:243], v[80:83]
  v_mfma_f32_4x4x4_16b_bf16 v[84:87], v[88:89], v[242:243], v[84:87]
  v_mfma_f32_4x4x4_16b_bf16 v[80:83], v[244:245], v[244:245], v[80:83]
  v_mfma_f32_4x4x4_16b_bf16 v[84:87], v[88:89], v[244:245], v[84:87]
  v_mfma_f32_4x4x4_16b_bf16 v[80:83], v[246:247], v[246:247], v[80:83]
  v_mfma_f32_4x4x4_16b_bf16 v[84:87], v[88:89], v[246:247], v[84:87]
  v_mfma_f32_4x4x4_16b_bf16 v[80:83], v[248:249], v[248:249], v[80:83]
  v_mfma_f32_4x4x4_16b_bf16 v[84:87], v[88:89], v[248:249], v[84:87]
  v_mfma_f32_4x4x4_16b_bf16 v[80:83], v[250:251], v[250:251], v[80:83]
  v_mfma_f32_4x4x4_16b_bf16 v[84:87], v[88:89], v[250:251], v[84:87]
  v_mfma_f32_4x4x4_16b_bf16 v[80:83], v[252:253], v[252:253], v[80:83]
  v_mfma_f32_4x4x4_16b_bf16 v[84:87], v[88:89], v[252:253], v[84:87]
  v_mfma_f32_4x4x4_16b_bf16 v[80:83], v[254:255], v[254:255], v[80:83]
  v_mfma_f32_4x4x4_16b_bf16 v[84:87], v[88:89], v[254:255], v[84:87]
  s_waitcnt lgkmcnt(2)
  v_mfma_f32_32x32x16_bf16 v[64:79], v[16:19], v[96:99], 0
  ds_read_b128 v[28:31], v4 offset:27648
  s_waitcnt lgkmcnt(2)
  v_mfma_f32_32x32x16_bf16 v[64:79], v[20:23], v[100:103], v[64:79]
  ds_read_b128 v[16:19], v4 offset:28672
  s_mov_b32 s66, 0xaaaaaaaa
  s_mov_b32 s67, 0xaaaaaaaa
  s_mov_b32 s68, 0xcccccccc
  s_mov_b32 s69, 0xcccccccc
  v_mov_b32 v85, v84
  s_waitcnt lgkmcnt(2)
  v_mfma_f32_32x32x16_bf16 v[64:79], v[24:27], v[104:107], v[64:79]
  ds_read_b128 v[20:23], v4 offset:29696
  v_cndmask_b32 v80, v80, v81, s[66:67]
  v_cndmask_b32 v82, v82, v83, s[66:67]
  v_permlane32_swap_b32 v85, v84
  v_cndmask_b32 v80, v80, v82, s[68:69]
  s_waitcnt lgkmcnt(2)
  v_mfma_f32_32x32x16_bf16 v[64:79], v[28:31], v[108:111], v[64:79]
  ds_read_b128 v[24:27], v4 offset:30720
  v_add_f32 v84, v84, v85
  v_mov_b32 v81, v80
  v_mul_f32 v84, 0x3acccccd, v84
  v_cvt_pk_bf16_f32 v12, -v84, -v84
  s_waitcnt lgkmcnt(2)
  v_mfma_f32_32x32x16_bf16 v[64:79], v[16:19], v[112:115], v[64:79]
  ds_read_b128 v[28:31], v4 offset:31744
  v_permlane32_swap_b32 v81, v80
  v_mov_b32 v13, v12
  v_mov_b32 v14, v12
  v_mov_b32 v15, v12
  s_waitcnt lgkmcnt(2)
  v_mfma_f32_32x32x16_bf16 v[64:79], v[20:23], v[116:119], v[64:79]
  ds_read_b128 v[16:19], v2 offset:0
  v_add_f32 v80, v80, v81
  v_mul_f32 v80, 0x3acccccd, v80
  v_fma_f32 v80, -v84, v84, v80
  v_max_f32 v80, 0, v80
  s_waitcnt lgkmcnt(2)
  v_mfma_f32_32x32x16_bf16 v[64:79], v[24:27], v[120:123], v[64:79]
  ds_read_b128 v[20:23], v2 offset:1024
  v_cvt_pk_bf16_f32 v80, 0, v80
  v_add_f32 v80, 0x3727c5ac, v80
  v_cvt_pk_bf16_f32 v80, 0, v80
  v_sqrt_f32 v80, v80
  s_waitcnt lgkmcnt(2)
  v_mfma_f32_32x32x16_bf16 v[64:79], v[28:31], v[124:127], v[64:79]
  ds_read_b128 v[24:27], v4 offset:32768
  v_cvt_pk_bf16_f32 v80, 0, v80
  v_rcp_f32 v80, v80
  s_nop 0
  v_mul_f32 v6, 0xbfb8aa3b, v80
  v_mul_f32 v7, v80, v80
  s_waitcnt lgkmcnt(2)
  v_mfma_f32_32x32x16_bf16 v[32:47], v[16:19], v[12:15], v[32:47]
  ds_read_b128 v[28:31], v4 offset:33792
  s_waitcnt lgkmcnt(2)
  v_mfma_f32_32x32x16_bf16 v[48:63], v[20:23], v[12:15], v[48:63]
  ds_read_b128 v[16:19], v4 offset:34816
  s_waitcnt lgkmcnt(2)
  v_mfma_f32_32x32x16_bf16 v[64:79], v[24:27], v[128:131], v[64:79]
  ds_read_b128 v[20:23], v4 offset:35840
  s_waitcnt lgkmcnt(2)
  v_mfma_f32_32x32x16_bf16 v[64:79], v[28:31], v[132:135], v[64:79]
  ds_read_b128 v[24:27], v4 offset:36864
  s_nop 1
  v_mul_f32 v40, v32, v40
  v_mul_f32 v32, v32, v6
  v_mul_f32 v41, v33, v41
  s_waitcnt lgkmcnt(2)
  v_mfma_f32_32x32x16_bf16 v[64:79], v[16:19], v[136:139], v[64:79]
  ds_read_b128 v[28:31], v4 offset:37888
  v_mul_f32 v40, v40, v7
  v_exp_f32 v32, v32
  v_mul_f32 v33, v33, v6
  s_waitcnt lgkmcnt(2)
  v_mfma_f32_32x32x16_bf16 v[64:79], v[20:23], v[140:143], v[64:79]
  ds_read_b128 v[16:19], v4 offset:38912
  v_mul_f32 v41, v41, v7
  v_mul_f32 v42, v34, v42
  v_add_f32 v32, 1.0, v32
  s_waitcnt lgkmcnt(2)
  v_mfma_f32_32x32x16_bf16 v[64:79], v[24:27], v[144:147], v[64:79]
  ds_read_b128 v[20:23], v4 offset:39936
  v_exp_f32 v33, v33
  v_mul_f32 v34, v34, v6
  v_rcp_f32 v32, v32
  s_waitcnt lgkmcnt(2)
  v_mfma_f32_32x32x16_bf16 v[64:79], v[28:31], v[148:151], v[64:79]
  ds_read_b128 v[24:27], v4 offset:40960
  v_mul_f32 v42, v42, v7
  v_add_f32 v33, 1.0, v33
  v_exp_f32 v34, v34
  s_waitcnt lgkmcnt(2)
  v_mfma_f32_32x32x16_bf16 v[64:79], v[16:19], v[152:155], v[64:79]
  ds_read_b128 v[28:31], v4 offset:41984
  v_mul_f32 v40, v40, v32
  v_rcp_f32 v33, v33
  v_mul_f32 v43, v35, v43
  s_waitcnt lgkmcnt(2)
  v_mfma_f32_32x32x16_bf16 v[64:79], v[20:23], v[156:159], v[64:79]
  ds_read_b128 v[16:19], v4 offset:43008
  v_add_f32 v34, 1.0, v34
  v_mul_f32 v35, v35, v6
  v_mul_f32 v41, v41, v33
  s_waitcnt lgkmcnt(2)
  v_mfma_f32_32x32x16_bf16 v[64:79], v[24:27], v[160:163], v[64:79]
  ds_read_b128 v[20:23], v4 offset:44032
  v_rcp_f32 v34, v34
  v_exp_f32 v35, v35
  v_cvt_pk_bf16_f32 v32, v40, v41
  s_waitcnt lgkmcnt(2)
  v_mfma_f32_32x32x16_bf16 v[64:79], v[28:31], v[164:167], v[64:79]
  ds_read_b128 v[24:27], v4 offset:45056
  v_mul_f32 v43, v43, v7
  v_mul_f32 v42, v42, v34
  v_add_f32 v35, 1.0, v35
  s_waitcnt lgkmcnt(2)
  v_mfma_f32_32x32x16_bf16 v[64:79], v[16:19], v[168:171], v[64:79]
  ds_read_b128 v[28:31], v4 offset:46080
  v_mul_f32 v44, v36, v44
  v_mul_f32 v36, v36, v6
  v_rcp_f32 v35, v35
  s_waitcnt lgkmcnt(2)
  v_mfma_f32_32x32x16_bf16 v[64:79], v[20:23], v[172:175], v[64:79]
  ds_read_b128 v[16:19], v4 offset:47104
  v_mul_f32 v44, v44, v7
  v_exp_f32 v36, v36
  v_mul_f32 v45, v37, v45
  s_waitcnt lgkmcnt(2)
  v_mfma_f32_32x32x16_bf16 v[64:79], v[24:27], v[176:179], v[64:79]
  ds_read_b128 v[20:23], v4 offset:48128
  v_mul_f32 v43, v43, v35
  v_mul_f32 v37, v37, v6
  v_add_f32 v36, 1.0, v36
  s_waitcnt lgkmcnt(2)
  v_mfma_f32_32x32x16_bf16 v[64:79], v[28:31], v[180:183], v[64:79]
  ds_read_b128 v[24:27], v4 offset:49152
  v_cvt_pk_bf16_f32 v33, v42, v43
  v_exp_f32 v37, v37
  v_rcp_f32 v36, v36
  s_waitcnt lgkmcnt(2)
  v_mfma_f32_32x32x16_bf16 v[64:79], v[16:19], v[184:187], v[64:79]
  ds_read_b128 v[28:31], v4 offset:50176
  v_mul_f32 v45, v45, v7
  v_mul_f32 v46, v38, v46
  v_add_f32 v37, 1.0, v37
  s_waitcnt lgkmcnt(2)
  v_mfma_f32_32x32x16_bf16 v[64:79], v[20:23], v[188:191], v[64:79]
  ds_read_b128 v[16:19], v4 offset:51200
  v_mul_f32 v44, v44, v36
  v_mul_f32 v38, v38, v6
  v_rcp_f32 v37, v37
  s_waitcnt lgkmcnt(2)
  v_mfma_f32_32x32x16_bf16 v[64:79], v[24:27], v[192:195], v[64:79]
  ds_read_b128 v[20:23], v4 offset:52224
  v_mul_f32 v46, v46, v7
  v_exp_f32 v38, v38
  v_mul_f32 v47, v39, v47
  s_waitcnt lgkmcnt(2)
  v_mfma_f32_32x32x16_bf16 v[64:79], v[28:31], v[196:199], v[64:79]
  ds_read_b128 v[24:27], v4 offset:53248
  v_mul_f32 v45, v45, v37
  v_mul_f32 v39, v39, v6
  v_add_f32 v38, 1.0, v38
  s_waitcnt lgkmcnt(2)
  v_mfma_f32_32x32x16_bf16 v[64:79], v[16:19], v[200:203], v[64:79]
  ds_read_b128 v[28:31], v4 offset:54272
  v_cvt_pk_bf16_f32 v34, v44, v45
  v_exp_f32 v39, v39
  v_rcp_f32 v38, v38
  s_waitcnt lgkmcnt(2)
  v_mfma_f32_32x32x16_bf16 v[64:79], v[20:23], v[204:207], v[64:79]
  ds_read_b128 v[16:19], v4 offset:55296
  v_mul_f32 v47, v47, v7
  v_mul_f32 v46, v46, v38
  v_add_f32 v39, 1.0, v39
  s_waitcnt lgkmcnt(2)
  v_mfma_f32_32x32x16_bf16 v[64:79], v[24:27], v[208:211], v[64:79]
  ds_read_b128 v[20:23], v4 offset:56320
  v_rcp_f32 v39, v39
  s_nop 0
  v_mul_f32 v47, v47, v39
  v_cvt_pk_bf16_f32 v35, v46, v47
  s_waitcnt lgkmcnt(2)
  v_mfma_f32_32x32x16_bf16 v[64:79], v[28:31], v[212:215], v[64:79]
  ds_read_b128 v[24:27], v4 offset:57344
  buffer_store_dwordx4 v[32:35], v8, s[48:51], s64 offen sc1
  s_add_u32 s64, s64, 512
  v_mul_f32 v56, v48, v56
  s_waitcnt lgkmcnt(2)
  v_mfma_f32_32x32x16_bf16 v[64:79], v[16:19], v[216:219], v[64:79]
  ds_read_b128 v[28:31], v4 offset:58368
  v_mul_f32 v48, v48, v6
  v_mul_f32 v57, v49, v57
  v_mul_f32 v56, v56, v7
  s_waitcnt lgkmcnt(2)
  v_mfma_f32_32x32x16_bf16 v[64:79], v[20:23], v[220:223], v[64:79]
  ds_read_b128 v[16:19], v4 offset:59392
  v_exp_f32 v48, v48
  v_mul_f32 v49, v49, v6
  v_mul_f32 v57, v57, v7
  s_waitcnt lgkmcnt(2)
  v_mfma_f32_32x32x16_bf16 v[64:79], v[24:27], v[224:227], v[64:79]
  ds_read_b128 v[20:23], v4 offset:60416
  v_mul_f32 v58, v50, v58
  v_add_f32 v48, 1.0, v48
  v_exp_f32 v49, v49
  s_waitcnt lgkmcnt(2)
  v_mfma_f32_32x32x16_bf16 v[64:79], v[28:31], v[228:231], v[64:79]
  ds_read_b128 v[24:27], v4 offset:61440
  v_mul_f32 v50, v50, v6
  v_rcp_f32 v48, v48
  v_mul_f32 v58, v58, v7
  s_waitcnt lgkmcnt(2)
  v_mfma_f32_32x32x16_bf16 v[64:79], v[16:19], v[232:235], v[64:79]
  ds_read_b128 v[28:31], v4 offset:62464
  v_add_f32 v49, 1.0, v49
  v_exp_f32 v50, v50
  v_mul_f32 v56, v56, v48
  s_waitcnt lgkmcnt(2)
  v_mfma_f32_32x32x16_bf16 v[64:79], v[20:23], v[236:239], v[64:79]
  ds_read_b128 v[16:19], v4 offset:63488
  v_rcp_f32 v49, v49
  v_mul_f32 v59, v51, v59
  v_add_f32 v50, 1.0, v50
  s_waitcnt lgkmcnt(2)
  v_mfma_f32_32x32x16_bf16 v[64:79], v[24:27], v[240:243], v[64:79]
  ds_read_b128 v[20:23], v4 offset:64512
  v_mul_f32 v51, v51, v6
  v_mul_f32 v57, v57, v49
  v_rcp_f32 v50, v50
  s_waitcnt lgkmcnt(2)
  v_mfma_f32_32x32x16_bf16 v[64:79], v[28:31], v[244:247], v[64:79]
  ds_read_b128 v[24:27], v2 offset:2048
  v_exp_f32 v51, v51
  v_cvt_pk_bf16_f32 v48, v56, v57
  v_mul_f32 v59, v59, v7
  s_waitcnt lgkmcnt(2)
  v_mfma_f32_32x32x16_bf16 v[64:79], v[16:19], v[248:251], v[64:79]
  s_barrier
  ds_read_b128 v[28:31], v5 offset:0
  v_mul_f32 v58, v58, v50
  v_add_f32 v51, 1.0, v51
  s_waitcnt lgkmcnt(2)
  v_mfma_f32_32x32x16_bf16 v[64:79], v[20:23], v[252:255], v[64:79]
  ds_read_b128 v[16:19], v5 offset:1024
  v_mul_f32 v60, v52, v60
  v_mul_f32 v52, v52, v6
  s_waitcnt lgkmcnt(2)
  v_mfma_f32_32x32x16_bf16 v[64:79], v[24:27], v[12:15], v[64:79]
  ds_read_b128 v[20:23], v5 offset:2048
  v_rcp_f32 v51, v51
  v_mul_f32 v60, v60, v7
  s_waitcnt lgkmcnt(2)
  v_mfma_f32_32x32x16_bf16 v[32:47], v[28:31], v[96:99], 0
  ds_read_b128 v[24:27], v5 offset:3072
  s_waitcnt lgkmcnt(2)
  v_mfma_f32_32x32x16_bf16 v[32:47], v[16:19], v[100:103], v[32:47]
  ds_read_b128 v[28:31], v5 offset:4096
  v_exp_f32 v52, v52
  v_mul_f32 v61, v53, v61
  v_mul_f32 v59, v59, v51
  s_waitcnt lgkmcnt(2)
  v_mfma_f32_32x32x16_bf16 v[32:47], v[20:23], v[104:107], v[32:47]
  ds_read_b128 v[16:19], v5 offset:5120
  v_mul_f32 v53, v53, v6
  v_add_f32 v52, 1.0, v52
  v_cvt_pk_bf16_f32 v49, v58, v59
  s_waitcnt lgkmcnt(2)
  v_mfma_f32_32x32x16_bf16 v[32:47], v[24:27], v[108:111], v[32:47]
  ds_read_b128 v[20:23], v5 offset:6144
  v_exp_f32 v53, v53
  v_rcp_f32 v52, v52
  v_mul_f32 v61, v61, v7
  s_waitcnt lgkmcnt(2)
  v_mfma_f32_32x32x16_bf16 v[32:47], v[28:31], v[112:115], v[32:47]
  ds_read_b128 v[24:27], v5 offset:7168
  v_mul_f32 v62, v54, v62
  v_add_f32 v53, 1.0, v53
  v_mul_f32 v60, v60, v52
  s_waitcnt lgkmcnt(2)
  v_mfma_f32_32x32x16_bf16 v[32:47], v[16:19], v[116:119], v[32:47]
  ds_read_b128 v[28:31], v5 offset:8192
  v_mul_f32 v54, v54, v6
  v_rcp_f32 v53, v53
  v_mul_f32 v62, v62, v7
  s_waitcnt lgkmcnt(2)
  v_mfma_f32_32x32x16_bf16 v[32:47], v[20:23], v[120:123], v[32:47]
  ds_read_b128 v[16:19], v5 offset:9216
  v_exp_f32 v54, v54
  v_mul_f32 v63, v55, v63
  v_mul_f32 v61, v61, v53
  s_waitcnt lgkmcnt(2)
  v_mfma_f32_32x32x16_bf16 v[32:47], v[24:27], v[124:127], v[32:47]
  ds_read_b128 v[20:23], v5 offset:10240
  v_mul_f32 v55, v55, v6
  v_add_f32 v54, 1.0, v54
  v_cvt_pk_bf16_f32 v50, v60, v61
  s_waitcnt lgkmcnt(2)
  v_mfma_f32_32x32x16_bf16 v[32:47], v[28:31], v[128:131], v[32:47]
  ds_read_b128 v[24:27], v5 offset:11264
  v_exp_f32 v55, v55
  v_rcp_f32 v54, v54
  v_mul_f32 v63, v63, v7
  s_waitcnt lgkmcnt(2)
  v_mfma_f32_32x32x16_bf16 v[32:47], v[16:19], v[132:135], v[32:47]
  ds_read_b128 v[28:31], v5 offset:12288
  v_mul_f32 v62, v62, v54
  v_add_f32 v55, 1.0, v55
  v_rcp_f32 v55, v55
  s_waitcnt lgkmcnt(2)
  v_mfma_f32_32x32x16_bf16 v[32:47], v[20:23], v[136:139], v[32:47]
  ds_read_b128 v[16:19], v5 offset:13312
  v_mul_f32 v63, v63, v55
  v_cvt_pk_bf16_f32 v51, v62, v63
  buffer_store_dwordx4 v[48:51], v8, s[48:51], s64 offen sc1
  s_waitcnt lgkmcnt(2)
  v_mfma_f32_32x32x16_bf16 v[32:47], v[24:27], v[140:143], v[32:47]
  ds_read_b128 v[20:23], v5 offset:14336
  s_add_u32 s64, s64, 512
  v_mul_f32 v72, v64, v72
  v_mul_f32 v64, v64, v6
  s_waitcnt lgkmcnt(2)
  v_mfma_f32_32x32x16_bf16 v[32:47], v[28:31], v[144:147], v[32:47]
  ds_read_b128 v[24:27], v5 offset:15360
  v_mul_f32 v73, v65, v73
  v_mul_f32 v72, v72, v7
  v_exp_f32 v64, v64
  s_waitcnt lgkmcnt(2)
  v_mfma_f32_32x32x16_bf16 v[32:47], v[16:19], v[148:151], v[32:47]
  ds_read_b128 v[28:31], v5 offset:16384
  v_mul_f32 v65, v65, v6
  v_mul_f32 v73, v73, v7
  v_mul_f32 v74, v66, v74
  s_waitcnt lgkmcnt(2)
  v_mfma_f32_32x32x16_bf16 v[32:47], v[20:23], v[152:155], v[32:47]
  ds_read_b128 v[16:19], v5 offset:17408
  v_add_f32 v64, 1.0, v64
  v_exp_f32 v65, v65
  s_waitcnt lgkmcnt(2)
  v_mfma_f32_32x32x16_bf16 v[32:47], v[24:27], v[156:159], v[32:47]
  ds_read_b128 v[20:23], v5 offset:18432
  v_mul_f32 v66, v66, v6
  v_rcp_f32 v64, v64
  s_waitcnt lgkmcnt(2)
  v_mfma_f32_32x32x16_bf16 v[32:47], v[28:31], v[160:163], v[32:47]
  ds_read_b128 v[24:27], v5 offset:19456
  v_mul_f32 v74, v74, v7
  v_add_f32 v65, 1.0, v65
  s_waitcnt lgkmcnt(2)
  v_mfma_f32_32x32x16_bf16 v[32:47], v[16:19], v[164:167], v[32:47]
  ds_read_b128 v[28:31], v5 offset:20480
  v_exp_f32 v66, v66
  v_mul_f32 v72, v72, v64
  s_waitcnt lgkmcnt(2)
  v_mfma_f32_32x32x16_bf16 v[32:47], v[20:23], v[168:171], v[32:47]
  ds_read_b128 v[16:19], v5 offset:21504
  v_rcp_f32 v65, v65
  v_mul_f32 v75, v67, v75
  s_waitcnt lgkmcnt(2)
  v_mfma_f32_32x32x16_bf16 v[32:47], v[24:27], v[172:175], v[32:47]
  ds_read_b128 v[20:23], v5 offset:22528
  v_add_f32 v66, 1.0, v66
  v_mul_f32 v67, v67, v6
  s_waitcnt lgkmcnt(2)
  v_mfma_f32_32x32x16_bf16 v[32:47], v[28:31], v[176:179], v[32:47]
  ds_read_b128 v[24:27], v5 offset:23552
  v_mul_f32 v73, v73, v65
  v_rcp_f32 v66, v66
  s_waitcnt lgkmcnt(2)
  v_mfma_f32_32x32x16_bf16 v[32:47], v[16:19], v[180:183], v[32:47]
  ds_read_b128 v[28:31], v5 offset:24576
  v_exp_f32 v67, v67
  v_cvt_pk_bf16_f32 v64, v72, v73
  s_waitcnt lgkmcnt(2)
  v_mfma_f32_32x32x16_bf16 v[32:47], v[20:23], v[184:187], v[32:47]
  ds_read_b128 v[16:19], v5 offset:25600
  v_mul_f32 v75, v75, v7
  v_mul_f32 v74, v74, v66
  s_waitcnt lgkmcnt(2)
  v_mfma_f32_32x32x16_bf16 v[32:47], v[24:27], v[188:191], v[32:47]
  ds_read_b128 v[20:23], v5 offset:26624
  v_add_f32 v67, 1.0, v67
  v_mul_f32 v76, v68, v76
  s_waitcnt lgkmcnt(2)
  v_mfma_f32_32x32x16_bf16 v[32:47], v[28:31], v[192:195], v[32:47]
  ds_read_b128 v[24:27], v5 offset:27648
  v_mul_f32 v68, v68, v6
  v_rcp_f32 v67, v67
  s_waitcnt lgkmcnt(2)
  v_mfma_f32_32x32x16_bf16 v[32:47], v[16:19], v[196:199], v[32:47]
  ds_read_b128 v[28:31], v5 offset:28672
  v_mul_f32 v76, v76, v7
  v_exp_f32 v68, v68
  s_waitcnt lgkmcnt(2)
  v_mfma_f32_32x32x16_bf16 v[32:47], v[20:23], v[200:203], v[32:47]
  ds_read_b128 v[16:19], v5 offset:29696
  v_mul_f32 v77, v69, v77
  v_mul_f32 v75, v75, v67
  s_waitcnt lgkmcnt(2)
  v_mfma_f32_32x32x16_bf16 v[32:47], v[24:27], v[204:207], v[32:47]
  ds_read_b128 v[20:23], v5 offset:30720
  v_mul_f32 v69, v69, v6
  v_add_f32 v68, 1.0, v68
  s_waitcnt lgkmcnt(2)
  v_mfma_f32_32x32x16_bf16 v[32:47], v[28:31], v[208:211], v[32:47]
  ds_read_b128 v[24:27], v5 offset:31744
  v_cvt_pk_bf16_f32 v65, v74, v75
  v_exp_f32 v69, v69
  s_waitcnt lgkmcnt(2)
  v_mfma_f32_32x32x16_bf16 v[32:47], v[16:19], v[212:215], v[32:47]
  ds_read_b128 v[28:31], v2 offset:8192
  v_rcp_f32 v68, v68
  v_mul_f32 v77, v77, v7
  s_waitcnt lgkmcnt(2)
  v_mfma_f32_32x32x16_bf16 v[32:47], v[20:23], v[216:219], v[32:47]
  ds_read_b128 v[16:19], v2 offset:9216
  v_mul_f32 v78, v70, v78
  v_add_f32 v69, 1.0, v69
  s_waitcnt lgkmcnt(2)
  v_mfma_f32_32x32x16_bf16 v[32:47], v[24:27], v[220:223], v[32:47]
  ds_read_b128 v[20:23], v2 offset:10240
  v_mul_f32 v76, v76, v68
  v_mul_f32 v70, v70, v6
  s_waitcnt lgkmcnt(2)
  v_mfma_f32_32x32x16_bf16 v[32:47], v[28:31], v[224:227], v[32:47]
  ds_read_b128 v[24:27], v2 offset:11264
  v_rcp_f32 v69, v69
  v_mul_f32 v78, v78, v7
  s_waitcnt lgkmcnt(2)
  v_mfma_f32_32x32x16_bf16 v[32:47], v[16:19], v[228:231], v[32:47]
  ds_read_b128 v[28:31], v2 offset:12288
  v_exp_f32 v70, v70
  v_mul_f32 v79, v71, v79
  s_waitcnt lgkmcnt(2)
  v_mfma_f32_32x32x16_bf16 v[32:47], v[20:23], v[232:235], v[32:47]
  ds_read_b128 v[16:19], v2 offset:13312
  v_mul_f32 v77, v77, v69
  v_mul_f32 v71, v71, v6
  s_waitcnt lgkmcnt(2)
  v_mfma_f32_32x32x16_bf16 v[32:47], v[24:27], v[236:239], v[32:47]
  ds_read_b128 v[20:23], v2 offset:14336
  v_add_f32 v70, 1.0, v70
  v_cvt_pk_bf16_f32 v66, v76, v77
  s_waitcnt lgkmcnt(2)
  v_mfma_f32_32x32x16_bf16 v[32:47], v[28:31], v[240:243], v[32:47]
  ds_read_b128 v[24:27], v2 offset:15360
  v_exp_f32 v71, v71
  v_rcp_f32 v70, v70
  s_waitcnt lgkmcnt(2)
  v_mfma_f32_32x32x16_bf16 v[32:47], v[16:19], v[244:247], v[32:47]
  ds_read_b128 v[28:31], v2 offset:3072
  v_mul_f32 v79, v79, v7
  v_mul_f32 v78, v78, v70
  s_waitcnt lgkmcnt(2)
  v_mfma_f32_32x32x16_bf16 v[32:47], v[20:23], v[248:251], v[32:47]
  s_barrier
  ds_read_b128 v[16:19], v2 offset:16384
  v_add_f32 v71, 1.0, v71
  v_rcp_f32 v71, v71
  s_waitcnt lgkmcnt(2)
  v_mfma_f32_32x32x16_bf16 v[32:47], v[24:27], v[252:255], v[32:47]
  ds_read_b128 v[20:23], v2 offset:17408
  v_mul_f32 v79, v79, v71
  v_cvt_pk_bf16_f32 v67, v78, v79
  s_waitcnt lgkmcnt(2)
  v_mfma_f32_32x32x16_bf16 v[32:47], v[28:31], v[12:15], v[32:47]
  ds_read_b128 v[24:27], v2 offset:18432
  buffer_store_dwordx4 v[64:67], v8, s[48:51], s64 offen sc1
  s_add_u32 s64, s64, 512
  s_waitcnt lgkmcnt(2)
  v_mfma_f32_32x32x16_bf16 v[48:63], v[16:19], v[96:99], 0
  ds_read_b128 v[28:31], v2 offset:19456
  s_waitcnt lgkmcnt(2)
  v_mfma_f32_32x32x16_bf16 v[48:63], v[20:23], v[100:103], v[48:63]
  ds_read_b128 v[16:19], v2 offset:20480
  s_nop 2
  v_mul_f32 v40, v32, v40
  v_mul_f32 v32, v32, v6
  s_waitcnt lgkmcnt(2)
  v_mfma_f32_32x32x16_bf16 v[48:63], v[24:27], v[104:107], v[48:63]
  ds_read_b128 v[20:23], v2 offset:21504
  v_mul_f32 v41, v33, v41
  v_mul_f32 v40, v40, v7
  s_waitcnt lgkmcnt(2)
  v_mfma_f32_32x32x16_bf16 v[48:63], v[28:31], v[108:111], v[48:63]
  ds_read_b128 v[24:27], v2 offset:22528
  v_exp_f32 v32, v32
  v_mul_f32 v33, v33, v6
  s_waitcnt lgkmcnt(2)
  v_mfma_f32_32x32x16_bf16 v[48:63], v[16:19], v[112:115], v[48:63]
  ds_read_b128 v[28:31], v2 offset:23552
  v_mul_f32 v41, v41, v7
  v_mul_f32 v42, v34, v42
  s_waitcnt lgkmcnt(2)
  v_mfma_f32_32x32x16_bf16 v[48:63], v[20:23], v[116:119], v[48:63]
  ds_read_b128 v[16:19], v2 offset:24576
  v_add_f32 v32, 1.0, v32
  v_exp_f32 v33, v33
  s_waitcnt lgkmcnt(2)
  v_mfma_f32_32x32x16_bf16 v[48:63], v[24:27], v[120:123], v[48:63]
  ds_read_b128 v[20:23], v2 offset:25600
  v_mul_f32 v34, v34, v6
  v_rcp_f32 v32, v32
  s_waitcnt lgkmcnt(2)
  v_mfma_f32_32x32x16_bf16 v[48:63], v[28:31], v[124:127], v[48:63]
  ds_read_b128 v[24:27], v2 offset:26624
  v_mul_f32 v42, v42, v7
  v_add_f32 v33, 1.0, v33
  s_waitcnt lgkmcnt(2)
  v_mfma_f32_32x32x16_bf16 v[48:63], v[16:19], v[128:131], v[48:63]
  ds_read_b128 v[28:31], v2 offset:27648
  v_exp_f32 v34, v34
  v_mul_f32 v40, v40, v32
  s_waitcnt lgkmcnt(2)
  v_mfma_f32_32x32x16_bf16 v[48:63], v[20:23], v[132:135], v[48:63]
  ds_read_b128 v[16:19], v2 offset:28672
  v_rcp_f32 v33, v33
  v_mul_f32 v43, v35, v43
  s_waitcnt lgkmcnt(2)
  v_mfma_f32_32x32x16_bf16 v[48:63], v[24:27], v[136:139], v[48:63]
  ds_read_b128 v[20:23], v2 offset:29696
  v_add_f32 v34, 1.0, v34
  v_mul_f32 v35, v35, v6
  s_waitcnt lgkmcnt(2)
  v_mfma_f32_32x32x16_bf16 v[48:63], v[28:31], v[140:143], v[48:63]
  ds_read_b128 v[24:27], v2 offset:30720
  v_mul_f32 v41, v41, v33
  v_rcp_f32 v34, v34
  s_waitcnt lgkmcnt(2)
  v_mfma_f32_32x32x16_bf16 v[48:63], v[16:19], v[144:147], v[48:63]
  ds_read_b128 v[28:31], v2 offset:31744
  v_exp_f32 v35, v35
  v_cvt_pk_bf16_f32 v32, v40, v41
  s_waitcnt lgkmcnt(2)
  v_mfma_f32_32x32x16_bf16 v[48:63], v[20:23], v[148:151], v[48:63]
  ds_read_b128 v[16:19], v2 offset:32768
  v_mul_f32 v43, v43, v7
  v_mul_f32 v42, v42, v34
  s_waitcnt lgkmcnt(2)
  v_mfma_f32_32x32x16_bf16 v[48:63], v[24:27], v[152:155], v[48:63]
  ds_read_b128 v[20:23], v2 offset:33792
  v_add_f32 v35, 1.0, v35
  v_mul_f32 v44, v36, v44
  s_waitcnt lgkmcnt(2)
  v_mfma_f32_32x32x16_bf16 v[48:63], v[28:31], v[156:159], v[48:63]
  ds_read_b128 v[24:27], v2 offset:34816
  v_mul_f32 v36, v36, v6
  v_rcp_f32 v35, v35
  s_waitcnt lgkmcnt(2)
  v_mfma_f32_32x32x16_bf16 v[48:63], v[16:19], v[160:163], v[48:63]
  ds_read_b128 v[28:31], v2 offset:35840
  v_mul_f32 v44, v44, v7
  v_exp_f32 v36, v36
  s_waitcnt lgkmcnt(2)
  v_mfma_f32_32x32x16_bf16 v[48:63], v[20:23], v[164:167], v[48:63]
  ds_read_b128 v[16:19], v2 offset:36864
  v_mul_f32 v45, v37, v45
  v_mul_f32 v43, v43, v35
  s_waitcnt lgkmcnt(2)
  v_mfma_f32_32x32x16_bf16 v[48:63], v[24:27], v[168:171], v[48:63]
  ds_read_b128 v[20:23], v2 offset:37888
  v_mul_f32 v37, v37, v6
  v_add_f32 v36, 1.0, v36
  s_waitcnt lgkmcnt(2)
  v_mfma_f32_32x32x16_bf16 v[48:63], v[28:31], v[172:175], v[48:63]
  ds_read_b128 v[24:27], v2 offset:38912
  v_cvt_pk_bf16_f32 v33, v42, v43
  v_exp_f32 v37, v37
  s_waitcnt lgkmcnt(2)
  v_mfma_f32_32x32x16_bf16 v[48:63], v[16:19], v[176:179], v[48:63]
  ds_read_b128 v[28:31], v2 offset:39936
  v_rcp_f32 v36, v36
  v_mul_f32 v45, v45, v7
  s_waitcnt lgkmcnt(2)
  v_mfma_f32_32x32x16_bf16 v[48:63], v[20:23], v[180:183], v[48:63]
  ds_read_b128 v[16:19], v2 offset:40960
  v_mul_f32 v46, v38, v46
  v_add_f32 v37, 1.0, v37
  s_waitcnt lgkmcnt(2)
  v_mfma_f32_32x32x16_bf16 v[48:63], v[24:27], v[184:187], v[48:63]
  ds_read_b128 v[20:23], v2 offset:41984
  v_mul_f32 v44, v44, v36
  v_mul_f32 v38, v38, v6
  s_waitcnt lgkmcnt(2)
  v_mfma_f32_32x32x16_bf16 v[48:63], v[28:31], v[188:191], v[48:63]
  ds_read_b128 v[24:27], v2 offset:43008
  v_rcp_f32 v37, v37
  v_mul_f32 v46, v46, v7
  s_waitcnt lgkmcnt(2)
  v_mfma_f32_32x32x16_bf16 v[48:63], v[16:19], v[192:195], v[48:63]
  ds_read_b128 v[28:31], v2 offset:44032
  v_exp_f32 v38, v38
  v_mul_f32 v47, v39, v47
  s_waitcnt lgkmcnt(2)
  v_mfma_f32_32x32x16_bf16 v[48:63], v[20:23], v[196:199], v[48:63]
  ds_read_b128 v[16:19], v2 offset:45056
  v_mul_f32 v45, v45, v37
  v_mul_f32 v39, v39, v6
  s_waitcnt lgkmcnt(2)
  v_mfma_f32_32x32x16_bf16 v[48:63], v[24:27], v[200:203], v[48:63]
  ds_read_b128 v[20:23], v2 offset:46080
  v_add_f32 v38, 1.0, v38
  v_cvt_pk_bf16_f32 v34, v44, v45
  s_waitcnt lgkmcnt(2)
  v_mfma_f32_32x32x16_bf16 v[48:63], v[28:31], v[204:207], v[48:63]
  ds_read_b128 v[24:27], v2 offset:47104
  v_exp_f32 v39, v39
  v_rcp_f32 v38, v38
  s_waitcnt lgkmcnt(2)
  v_mfma_f32_32x32x16_bf16 v[48:63], v[16:19], v[208:211], v[48:63]
  ds_read_b128 v[28:31], v2 offset:48128
  v_mul_f32 v47, v47, v7
  v_mul_f32 v46, v46, v38
  s_waitcnt lgkmcnt(2)
  v_mfma_f32_32x32x16_bf16 v[48:63], v[20:23], v[212:215], v[48:63]
  ds_read_b128 v[16:19], v2 offset:49152
  v_add_f32 v39, 1.0, v39
  v_rcp_f32 v39, v39
  s_waitcnt lgkmcnt(2)
  v_mfma_f32_32x32x16_bf16 v[48:63], v[24:27], v[216:219], v[48:63]
  ds_read_b128 v[20:23], v2 offset:50176
  v_mul_f32 v47, v47, v39
  v_cvt_pk_bf16_f32 v35, v46, v47
  s_waitcnt lgkmcnt(2)
  v_mfma_f32_32x32x16_bf16 v[48:63], v[28:31], v[220:223], v[48:63]
  ds_read_b128 v[24:27], v2 offset:51200
  buffer_store_dwordx4 v[32:35], v8, s[48:51], s64 offen sc1
  s_waitcnt lgkmcnt(2)
  v_mfma_f32_32x32x16_bf16 v[48:63], v[16:19], v[224:227], v[48:63]
  ds_read_b128 v[28:31], v2 offset:52224
  s_add_u32 s64, s64, 512
  s_waitcnt lgkmcnt(2)
  v_mfma_f32_32x32x16_bf16 v[48:63], v[20:23], v[228:231], v[48:63]
  ds_read_b128 v[16:19], v2 offset:53248
  s_waitcnt lgkmcnt(2)
  v_mfma_f32_32x32x16_bf16 v[48:63], v[24:27], v[232:235], v[48:63]
  ds_read_b128 v[20:23], v2 offset:54272
  s_waitcnt lgkmcnt(2)
  v_mfma_f32_32x32x16_bf16 v[48:63], v[28:31], v[236:239], v[48:63]
  ds_read_b128 v[24:27], v2 offset:55296
  s_waitcnt lgkmcnt(2)
  v_mfma_f32_32x32x16_bf16 v[48:63], v[16:19], v[240:243], v[48:63]
  ds_read_b128 v[28:31], v2 offset:56320
  s_waitcnt lgkmcnt(2)
  v_mfma_f32_32x32x16_bf16 v[48:63], v[20:23], v[244:247], v[48:63]
  ds_read_b128 v[16:19], v2 offset:4096
  s_waitcnt lgkmcnt(2)
  v_mfma_f32_32x32x16_bf16 v[48:63], v[24:27], v[248:251], v[48:63]
  s_barrier
  ds_read_b128 v[20:23], v2 offset:57344
  s_waitcnt lgkmcnt(2)
  v_mfma_f32_32x32x16_bf16 v[48:63], v[28:31], v[252:255], v[48:63]
  ds_read_b128 v[24:27], v2 offset:58368
  s_waitcnt lgkmcnt(2)
  v_mfma_f32_32x32x16_bf16 v[48:63], v[16:19], v[12:15], v[48:63]
  ds_read_b128 v[28:31], v2 offset:59392
  s_waitcnt lgkmcnt(2)
  v_mfma_f32_32x32x16_bf16 v[64:79], v[20:23], v[96:99], 0
  ds_read_b128 v[16:19], v2 offset:60416
  s_waitcnt lgkmcnt(2)
  v_mfma_f32_32x32x16_bf16 v[64:79], v[24:27], v[100:103], v[64:79]
  ds_read_b128 v[20:23], v2 offset:61440
  s_nop 4
  v_mul_f32 v56, v48, v56
  v_mul_f32 v48, v48, v6
  v_mul_f32 v57, v49, v57
  v_mul_f32 v56, v56, v7
  s_waitcnt lgkmcnt(2)
  v_mfma_f32_32x32x16_bf16 v[64:79], v[28:31], v[104:107], v[64:79]
  ds_read_b128 v[24:27], v2 offset:62464
  v_exp_f32 v48, v48
  v_mul_f32 v49, v49, v6
  v_mul_f32 v57, v57, v7
  v_mul_f32 v58, v50, v58
  s_waitcnt lgkmcnt(2)
  v_mfma_f32_32x32x16_bf16 v[64:79], v[16:19], v[108:111], v[64:79]
  ds_read_b128 v[28:31], v2 offset:63488
  v_add_f32 v48, 1.0, v48
  v_exp_f32 v49, v49
  v_mul_f32 v50, v50, v6
  s_waitcnt lgkmcnt(2)
  v_mfma_f32_32x32x16_bf16 v[64:79], v[20:23], v[112:115], v[64:79]
  ds_read_b128 v[16:19], v2 offset:64512
  v_rcp_f32 v48, v48
  v_mul_f32 v58, v58, v7
  v_add_f32 v49, 1.0, v49
  s_waitcnt lgkmcnt(2)
  v_mfma_f32_32x32x16_bf16 v[64:79], v[24:27], v[116:119], v[64:79]
  ds_read_b128 v[20:23], v4 offset:0
  v_exp_f32 v50, v50
  v_mul_f32 v56, v56, v48
  v_rcp_f32 v49, v49
  s_waitcnt lgkmcnt(2)
  v_mfma_f32_32x32x16_bf16 v[64:79], v[28:31], v[120:123], v[64:79]
  ds_read_b128 v[24:27], v4 offset:1024
  v_mul_f32 v59, v51, v59
  v_add_f32 v50, 1.0, v50
  v_mul_f32 v51, v51, v6
  s_waitcnt lgkmcnt(2)
  v_mfma_f32_32x32x16_bf16 v[64:79], v[16:19], v[124:127], v[64:79]
  ds_read_b128 v[28:31], v4 offset:2048
  v_mul_f32 v57, v57, v49
  v_rcp_f32 v50, v50
  v_exp_f32 v51, v51
  s_waitcnt lgkmcnt(2)
  v_mfma_f32_32x32x16_bf16 v[64:79], v[20:23], v[128:131], v[64:79]
  ds_read_b128 v[16:19], v4 offset:3072
  v_cvt_pk_bf16_f32 v48, v56, v57
  v_mul_f32 v59, v59, v7
  v_mul_f32 v58, v58, v50
  s_waitcnt lgkmcnt(2)
  v_mfma_f32_32x32x16_bf16 v[64:79], v[24:27], v[132:135], v[64:79]
  ds_read_b128 v[20:23], v4 offset:4096
  v_add_f32 v51, 1.0, v51
  v_mul_f32 v60, v52, v60
  v_mul_f32 v52, v52, v6
  s_waitcnt lgkmcnt(2)
  v_mfma_f32_32x32x16_bf16 v[64:79], v[28:31], v[136:139], v[64:79]
  ds_read_b128 v[24:27], v4 offset:5120
  v_rcp_f32 v51, v51
  v_mul_f32 v60, v60, v7
  v_exp_f32 v52, v52
  s_waitcnt lgkmcnt(2)
  v_mfma_f32_32x32x16_bf16 v[64:79], v[16:19], v[140:143], v[64:79]
  ds_read_b128 v[28:31], v4 offset:6144
  v_mul_f32 v61, v53, v61
  v_mul_f32 v59, v59, v51
  v_mul_f32 v53, v53, v6
  s_waitcnt lgkmcnt(2)
  v_mfma_f32_32x32x16_bf16 v[64:79], v[20:23], v[144:147], v[64:79]
  ds_read_b128 v[16:19], v4 offset:7168
  v_add_f32 v52, 1.0, v52
  v_cvt_pk_bf16_f32 v49, v58, v59
  v_exp_f32 v53, v53
  s_waitcnt lgkmcnt(2)
  v_mfma_f32_32x32x16_bf16 v[64:79], v[24:27], v[148:151], v[64:79]
  ds_read_b128 v[20:23], v4 offset:8192
  v_rcp_f32 v52, v52
  v_mul_f32 v61, v61, v7
  v_mul_f32 v62, v54, v62
  s_waitcnt lgkmcnt(2)
  v_mfma_f32_32x32x16_bf16 v[64:79], v[28:31], v[152:155], v[64:79]
  ds_read_b128 v[24:27], v4 offset:9216
  v_add_f32 v53, 1.0, v53
  v_mul_f32 v60, v60, v52
  v_mul_f32 v54, v54, v6
  s_waitcnt lgkmcnt(2)
  v_mfma_f32_32x32x16_bf16 v[64:79], v[16:19], v[156:159], v[64:79]
  ds_read_b128 v[28:31], v4 offset:10240
  v_rcp_f32 v53, v53
  v_mul_f32 v62, v62, v7
  v_exp_f32 v54, v54
  s_waitcnt lgkmcnt(2)
  v_mfma_f32_32x32x16_bf16 v[64:79], v[20:23], v[160:163], v[64:79]
  ds_read_b128 v[16:19], v4 offset:11264
  v_mul_f32 v63, v55, v63
  v_mul_f32 v61, v61, v53
  v_mul_f32 v55, v55, v6
  s_waitcnt lgkmcnt(2)
  v_mfma_f32_32x32x16_bf16 v[64:79], v[24:27], v[164:167], v[64:79]
  ds_read_b128 v[20:23], v4 offset:12288
  v_add_f32 v54, 1.0, v54
  v_cvt_pk_bf16_f32 v50, v60, v61
  v_exp_f32 v55, v55
  s_waitcnt lgkmcnt(2)
  v_mfma_f32_32x32x16_bf16 v[64:79], v[28:31], v[168:171], v[64:79]
  ds_read_b128 v[24:27], v4 offset:13312
  v_rcp_f32 v54, v54
  v_mul_f32 v63, v63, v7
  v_mul_f32 v62, v62, v54
  s_waitcnt lgkmcnt(2)
  v_mfma_f32_32x32x16_bf16 v[64:79], v[16:19], v[172:175], v[64:79]
  ds_read_b128 v[28:31], v4 offset:14336
  v_add_f32 v55, 1.0, v55
  v_rcp_f32 v55, v55
  s_nop 0
  v_mul_f32 v63, v63, v55
  s_waitcnt lgkmcnt(2)
  v_mfma_f32_32x32x16_bf16 v[64:79], v[20:23], v[176:179], v[64:79]
  ds_read_b128 v[16:19], v4 offset:15360
  v_cvt_pk_bf16_f32 v51, v62, v63
  buffer_store_dwordx4 v[48:51], v8, s[48:51], s64 offen sc1
  s_add_u32 s64, s64, s71
  s_waitcnt lgkmcnt(2)
  v_mfma_f32_32x32x16_bf16 v[64:79], v[24:27], v[180:183], v[64:79]
  ds_read_b128 v[20:23], v4 offset:16384
  s_waitcnt lgkmcnt(2)
  v_mfma_f32_32x32x16_bf16 v[64:79], v[28:31], v[184:187], v[64:79]
  ds_read_b128 v[24:27], v4 offset:17408
  s_waitcnt lgkmcnt(2)
  v_mfma_f32_32x32x16_bf16 v[64:79], v[16:19], v[188:191], v[64:79]
  ds_read_b128 v[28:31], v4 offset:18432
  s_waitcnt lgkmcnt(2)
  v_mfma_f32_32x32x16_bf16 v[64:79], v[20:23], v[192:195], v[64:79]
  ds_read_b128 v[16:19], v4 offset:19456
  s_waitcnt lgkmcnt(2)
  v_mfma_f32_32x32x16_bf16 v[64:79], v[24:27], v[196:199], v[64:79]
  ds_read_b128 v[20:23], v4 offset:20480
  s_waitcnt lgkmcnt(2)
  v_mfma_f32_32x32x16_bf16 v[64:79], v[28:31], v[200:203], v[64:79]
  ds_read_b128 v[24:27], v4 offset:21504
  s_waitcnt lgkmcnt(2)
  v_mfma_f32_32x32x16_bf16 v[64:79], v[16:19], v[204:207], v[64:79]
  ds_read_b128 v[28:31], v4 offset:22528
  s_waitcnt lgkmcnt(2)
  v_mfma_f32_32x32x16_bf16 v[64:79], v[20:23], v[208:211], v[64:79]
  ds_read_b128 v[16:19], v4 offset:23552
  s_waitcnt lgkmcnt(2)
  v_mfma_f32_32x32x16_bf16 v[64:79], v[24:27], v[212:215], v[64:79]
  ds_read_b128 v[20:23], v4 offset:24576
  s_waitcnt lgkmcnt(2)
  v_mfma_f32_32x32x16_bf16 v[64:79], v[28:31], v[216:219], v[64:79]
  ds_read_b128 v[24:27], v4 offset:25600
  s_waitcnt lgkmcnt(2)
  v_mfma_f32_32x32x16_bf16 v[64:79], v[16:19], v[220:223], v[64:79]
  ds_read_b128 v[28:31], v4 offset:26624
  s_waitcnt lgkmcnt(2)
  v_mfma_f32_32x32x16_bf16 v[64:79], v[20:23], v[224:227], v[64:79]
  ds_read_b128 v[16:19], v4 offset:27648
  s_waitcnt lgkmcnt(2)
  v_mfma_f32_32x32x16_bf16 v[64:79], v[24:27], v[228:231], v[64:79]
  ds_read_b128 v[20:23], v4 offset:28672
  s_waitcnt lgkmcnt(2)
  v_mfma_f32_32x32x16_bf16 v[64:79], v[28:31], v[232:235], v[64:79]
  ds_read_b128 v[24:27], v4 offset:29696
  s_waitcnt lgkmcnt(2)
  v_mfma_f32_32x32x16_bf16 v[64:79], v[16:19], v[236:239], v[64:79]
  ds_read_b128 v[28:31], v4 offset:30720
  s_waitcnt lgkmcnt(2)
  v_mfma_f32_32x32x16_bf16 v[64:79], v[20:23], v[240:243], v[64:79]
  ds_read_b128 v[16:19], v4 offset:31744
  s_waitcnt lgkmcnt(2)
  v_mfma_f32_32x32x16_bf16 v[64:79], v[24:27], v[244:247], v[64:79]
  ds_read_b128 v[20:23], v2 offset:5120
  s_waitcnt lgkmcnt(2)
  v_mfma_f32_32x32x16_bf16 v[64:79], v[28:31], v[248:251], v[64:79]
  s_barrier
  ds_read_b128 v[24:27], v4 offset:32768
  s_waitcnt lgkmcnt(2)
  v_mfma_f32_32x32x16_bf16 v[64:79], v[16:19], v[252:255], v[64:79]
  ds_read_b128 v[28:31], v4 offset:33792
  s_waitcnt lgkmcnt(2)
  v_mfma_f32_32x32x16_bf16 v[64:79], v[20:23], v[12:15], v[64:79]
  ds_read_b128 v[16:19], v4 offset:34816
  s_waitcnt lgkmcnt(2)
  v_mfma_f32_32x32x16_bf16 v[32:47], v[24:27], v[96:99], 0
  ds_read_b128 v[20:23], v4 offset:35840
  s_waitcnt lgkmcnt(2)
  v_mfma_f32_32x32x16_bf16 v[32:47], v[28:31], v[100:103], v[32:47]
  ds_read_b128 v[24:27], v4 offset:36864
  s_nop 4
  v_mul_f32 v72, v64, v72
  v_mul_f32 v64, v64, v6
  s_waitcnt lgkmcnt(2)
  v_mfma_f32_32x32x16_bf16 v[32:47], v[16:19], v[104:107], v[32:47]
  ds_read_b128 v[28:31], v4 offset:37888
  v_mul_f32 v73, v65, v73
  v_mul_f32 v72, v72, v7
  s_waitcnt lgkmcnt(2)
  v_mfma_f32_32x32x16_bf16 v[32:47], v[20:23], v[108:111], v[32:47]
  ds_read_b128 v[16:19], v4 offset:38912
  v_exp_f32 v64, v64
  v_mul_f32 v65, v65, v6
  s_waitcnt lgkmcnt(2)
  v_mfma_f32_32x32x16_bf16 v[32:47], v[24:27], v[112:115], v[32:47]
  ds_read_b128 v[20:23], v4 offset:39936
  v_mul_f32 v73, v73, v7
  v_mul_f32 v74, v66, v74
  s_waitcnt lgkmcnt(2)
  v_mfma_f32_32x32x16_bf16 v[32:47], v[28:31], v[116:119], v[32:47]
  ds_read_b128 v[24:27], v4 offset:40960
  v_add_f32 v64, 1.0, v64
  v_exp_f32 v65, v65
  s_waitcnt lgkmcnt(2)
  v_mfma_f32_32x32x16_bf16 v[32:47], v[16:19], v[120:123], v[32:47]
  ds_read_b128 v[28:31], v4 offset:41984
  v_mul_f32 v66, v66, v6
  v_rcp_f32 v64, v64
  s_waitcnt lgkmcnt(2)
  v_mfma_f32_32x32x16_bf16 v[32:47], v[20:23], v[124:127], v[32:47]
  ds_read_b128 v[16:19], v4 offset:43008
  v_mul_f32 v74, v74, v7
  v_add_f32 v65, 1.0, v65
  s_waitcnt lgkmcnt(2)
  v_mfma_f32_32x32x16_bf16 v[32:47], v[24:27], v[128:131], v[32:47]
  ds_read_b128 v[20:23], v4 offset:44032
  s_waitcnt vmcnt(0)
  s_barrier
  v_exp_f32 v66, v66
  v_mul_f32 v72, v72, v64
  s_waitcnt lgkmcnt(2)
  v_mfma_f32_32x32x16_bf16 v[32:47], v[28:31], v[132:135], v[32:47]
  ds_read_b128 v[24:27], v4 offset:45056
  v_rcp_f32 v65, v65
  v_mul_f32 v75, v67, v75
  s_waitcnt lgkmcnt(2)
  v_mfma_f32_32x32x16_bf16 v[32:47], v[16:19], v[136:139], v[32:47]
  ds_read_b128 v[28:31], v4 offset:46080
  v_add_f32 v66, 1.0, v66
  v_mul_f32 v67, v67, v6
  s_waitcnt lgkmcnt(2)
  v_mfma_f32_32x32x16_bf16 v[32:47], v[20:23], v[140:143], v[32:47]
  ds_read_b128 v[16:19], v4 offset:47104
  v_mul_f32 v73, v73, v65
  v_rcp_f32 v66, v66
  s_waitcnt lgkmcnt(2)
  v_mfma_f32_32x32x16_bf16 v[32:47], v[24:27], v[144:147], v[32:47]
  ds_read_b128 v[20:23], v4 offset:48128
  v_exp_f32 v67, v67
  v_cvt_pk_bf16_f32 v64, v72, v73
  s_waitcnt lgkmcnt(2)
  v_mfma_f32_32x32x16_bf16 v[32:47], v[28:31], v[148:151], v[32:47]
  ds_read_b128 v[24:27], v4 offset:49152
  v_mul_f32 v75, v75, v7
  v_mul_f32 v74, v74, v66
  s_waitcnt lgkmcnt(2)
  v_mfma_f32_32x32x16_bf16 v[32:47], v[16:19], v[152:155], v[32:47]
  ds_read_b128 v[28:31], v4 offset:50176
  v_add_f32 v67, 1.0, v67
  v_mul_f32 v76, v68, v76
  s_waitcnt lgkmcnt(2)
  v_mfma_f32_32x32x16_bf16 v[32:47], v[20:23], v[156:159], v[32:47]
  ds_read_b128 v[16:19], v4 offset:51200
  v_mul_f32 v68, v68, v6
  v_rcp_f32 v67, v67
  s_waitcnt lgkmcnt(2)
  v_mfma_f32_32x32x16_bf16 v[32:47], v[24:27], v[160:163], v[32:47]
  ds_read_b128 v[20:23], v4 offset:52224
  v_mul_f32 v76, v76, v7
  v_exp_f32 v68, v68
  s_waitcnt lgkmcnt(2)
  v_mfma_f32_32x32x16_bf16 v[32:47], v[28:31], v[164:167], v[32:47]
  ds_read_b128 v[24:27], v4 offset:53248
  v_mul_f32 v77, v69, v77
  v_mul_f32 v75, v75, v67
  s_waitcnt lgkmcnt(2)
  v_mfma_f32_32x32x16_bf16 v[32:47], v[16:19], v[168:171], v[32:47]
  ds_read_b128 v[28:31], v4 offset:54272
  v_mul_f32 v69, v69, v6
  v_add_f32 v68, 1.0, v68
  s_waitcnt lgkmcnt(2)
  v_mfma_f32_32x32x16_bf16 v[32:47], v[20:23], v[172:175], v[32:47]
  ds_read_b128 v[16:19], v4 offset:55296
  v_cvt_pk_bf16_f32 v65, v74, v75
  v_exp_f32 v69, v69
  s_waitcnt lgkmcnt(2)
  v_mfma_f32_32x32x16_bf16 v[32:47], v[24:27], v[176:179], v[32:47]
  ds_read_b128 v[20:23], v4 offset:56320
  v_rcp_f32 v68, v68
  v_mul_f32 v77, v77, v7
  s_waitcnt lgkmcnt(2)
  v_mfma_f32_32x32x16_bf16 v[32:47], v[28:31], v[180:183], v[32:47]
  ds_read_b128 v[24:27], v4 offset:57344
  v_mul_f32 v78, v70, v78
  v_add_f32 v69, 1.0, v69
  s_waitcnt lgkmcnt(2)
  v_mfma_f32_32x32x16_bf16 v[32:47], v[16:19], v[184:187], v[32:47]
  ds_read_b128 v[28:31], v4 offset:58368
  v_mul_f32 v76, v76, v68
  v_mul_f32 v70, v70, v6
  s_waitcnt lgkmcnt(2)
  v_mfma_f32_32x32x16_bf16 v[32:47], v[20:23], v[188:191], v[32:47]
  ds_read_b128 v[16:19], v4 offset:59392
  v_rcp_f32 v69, v69
  v_mul_f32 v78, v78, v7
  s_waitcnt lgkmcnt(2)
  v_mfma_f32_32x32x16_bf16 v[32:47], v[24:27], v[192:195], v[32:47]
  ds_read_b128 v[20:23], v4 offset:60416
  v_exp_f32 v70, v70
  v_mul_f32 v79, v71, v79
  s_waitcnt lgkmcnt(2)
  v_mfma_f32_32x32x16_bf16 v[32:47], v[28:31], v[196:199], v[32:47]
  ds_read_b128 v[24:27], v4 offset:61440
  v_mul_f32 v77, v77, v69
  v_mul_f32 v71, v71, v6
  s_waitcnt lgkmcnt(2)
  v_mfma_f32_32x32x16_bf16 v[32:47], v[16:19], v[200:203], v[32:47]
  ds_read_b128 v[28:31], v4 offset:62464
  v_add_f32 v70, 1.0, v70
  v_cvt_pk_bf16_f32 v66, v76, v77
  s_waitcnt lgkmcnt(2)
  v_mfma_f32_32x32x16_bf16 v[32:47], v[20:23], v[204:207], v[32:47]
  ds_read_b128 v[16:19], v4 offset:63488
  v_exp_f32 v71, v71
  v_rcp_f32 v70, v70
  s_waitcnt lgkmcnt(2)
  v_mfma_f32_32x32x16_bf16 v[32:47], v[24:27], v[208:211], v[32:47]
  ds_read_b128 v[20:23], v4 offset:64512
  v_mul_f32 v79, v79, v7
  v_mul_f32 v78, v78, v70
  s_waitcnt lgkmcnt(2)
  v_mfma_f32_32x32x16_bf16 v[32:47], v[28:31], v[212:215], v[32:47]
  ds_read_b128 v[24:27], v2 offset:8192
  v_add_f32 v71, 1.0, v71
  v_rcp_f32 v71, v71
  s_waitcnt lgkmcnt(2)
  v_mfma_f32_32x32x16_bf16 v[32:47], v[16:19], v[216:219], v[32:47]
  ds_read_b128 v[28:31], v2 offset:9216
  v_mul_f32 v79, v79, v71
  v_cvt_pk_bf16_f32 v67, v78, v79
  s_waitcnt lgkmcnt(2)
  v_mfma_f32_32x32x16_bf16 v[32:47], v[20:23], v[220:223], v[32:47]
  ds_read_b128 v[16:19], v2 offset:10240
  buffer_store_dwordx4 v[64:67], v8, s[48:51], s64 offen sc1
  s_waitcnt lgkmcnt(2)
  v_mfma_f32_32x32x16_bf16 v[32:47], v[24:27], v[224:227], v[32:47]
  ds_read_b128 v[20:23], v2 offset:11264
  s_add_u32 s64, s64, 512
  s_waitcnt lgkmcnt(2)
  v_mfma_f32_32x32x16_bf16 v[32:47], v[28:31], v[228:231], v[32:47]
  ds_read_b128 v[24:27], v2 offset:12288
  s_waitcnt lgkmcnt(2)
  v_mfma_f32_32x32x16_bf16 v[32:47], v[16:19], v[232:235], v[32:47]
  ds_read_b128 v[28:31], v2 offset:13312
  s_waitcnt lgkmcnt(2)
  v_mfma_f32_32x32x16_bf16 v[32:47], v[20:23], v[236:239], v[32:47]
  ds_read_b128 v[16:19], v2 offset:14336
  s_waitcnt lgkmcnt(2)
  v_mfma_f32_32x32x16_bf16 v[32:47], v[24:27], v[240:243], v[32:47]
  ds_read_b128 v[20:23], v2 offset:15360
  s_waitcnt lgkmcnt(2)
  v_mfma_f32_32x32x16_bf16 v[32:47], v[28:31], v[244:247], v[32:47]
  ds_read_b128 v[24:27], v2 offset:6144
  s_waitcnt lgkmcnt(2)
  v_mfma_f32_32x32x16_bf16 v[32:47], v[16:19], v[248:251], v[32:47]
  s_waitcnt lgkmcnt(1)
  v_mfma_f32_32x32x16_bf16 v[32:47], v[20:23], v[252:255], v[32:47]
  s_waitcnt lgkmcnt(0)
  v_mfma_f32_32x32x16_bf16 v[32:47], v[24:27], v[12:15], v[32:47]
  v_mul_f32 v7, s70, v7
  s_nop 10
  v_mul_f32 v40, v32, v40
  v_mul_f32 v32, v32, v6
  v_mul_f32 v41, v33, v41
  v_mul_f32 v40, v40, v7
  v_exp_f32 v32, v32
  v_mul_f32 v33, v33, v6
  v_mul_f32 v41, v41, v7
  v_mul_f32 v42, v34, v42
  v_add_f32 v32, 1.0, v32
  v_exp_f32 v33, v33
  v_mul_f32 v34, v34, v6
  v_rcp_f32 v32, v32
  v_mul_f32 v42, v42, v7
  v_add_f32 v33, 1.0, v33
  v_exp_f32 v34, v34
  v_mul_f32 v40, v40, v32
  v_rcp_f32 v33, v33
  v_mul_f32 v43, v35, v43
  v_add_f32 v34, 1.0, v34
  v_mul_f32 v35, v35, v6
  v_mul_f32 v41, v41, v33
  v_rcp_f32 v34, v34
  v_exp_f32 v35, v35
  v_cvt_pk_bf16_f32 v32, v40, v41
  v_mul_f32 v43, v43, v7
  v_mul_f32 v42, v42, v34
  v_add_f32 v35, 1.0, v35
  v_mul_f32 v44, v36, v44
  v_mul_f32 v36, v36, v6
  v_rcp_f32 v35, v35
  v_mul_f32 v44, v44, v7
  v_exp_f32 v36, v36
  v_mul_f32 v45, v37, v45
  v_mul_f32 v43, v43, v35
  v_mul_f32 v37, v37, v6
  v_add_f32 v36, 1.0, v36
  v_cvt_pk_bf16_f32 v33, v42, v43
  v_exp_f32 v37, v37
  v_rcp_f32 v36, v36
  v_mul_f32 v45, v45, v7
  v_mul_f32 v46, v38, v46
  v_add_f32 v37, 1.0, v37
  v_mul_f32 v44, v44, v36
  v_mul_f32 v38, v38, v6
  v_rcp_f32 v37, v37
  v_mul_f32 v46, v46, v7
  v_exp_f32 v38, v38
  v_mul_f32 v47, v39, v47
  v_mul_f32 v45, v45, v37
  v_mul_f32 v39, v39, v6
  v_add_f32 v38, 1.0, v38
  v_cvt_pk_bf16_f32 v34, v44, v45
  v_exp_f32 v39, v39
  v_rcp_f32 v38, v38
  v_mul_f32 v47, v47, v7
  v_mul_f32 v46, v46, v38
  v_add_f32 v39, 1.0, v39
  v_rcp_f32 v39, v39
  s_nop 0
  v_mul_f32 v47, v47, v39
  v_cvt_pk_bf16_f32 v35, v46, v47
  buffer_store_dwordx4 v[32:35], v8, s[48:51], s64 offen sc1
  buffer_load_dwordx4 v[96:99], v2, s[52:55], s62 offen offset:0 sc1
  buffer_load_dwordx4 v[100:103], v2, s[52:55], s62 offen offset:1024 sc1
  buffer_load_dwordx4 v[104:107], v2, s[52:55], s62 offen offset:2048 sc1
  buffer_load_dwordx4 v[108:111], v2, s[52:55], s62 offen offset:3072 sc1
  buffer_load_dwordx4 v[112:115], v3, s[52:55], s62 offen offset:0 sc1
  s_add_u32 s62, s62, 40960
  buffer_load_dwordx4 v[116:119], v2, s[52:55], s62 offen offset:0 sc1
  buffer_load_dwordx4 v[120:123], v2, s[52:55], s62 offen offset:1024 sc1
  buffer_load_dwordx4 v[124:127], v2, s[52:55], s62 offen offset:2048 sc1
  buffer_load_dwordx4 v[128:131], v2, s[52:55], s62 offen offset:3072 sc1
  buffer_load_dwordx4 v[132:135], v3, s[52:55], s62 offen offset:0 sc1
  s_add_u32 s62, s62, 40960
  s_add_u32 s66, s3, 0
  s_and_b32 s66, s66, 3
  s_mul_i32 s66, s66, 57344
  v_add_u32 v255, s66, v2
  s_add_u32 s66, s3, 1
  s_and_b32 s66, s66, 3
  s_mul_i32 s66, s66, 57344
  v_add_u32 v4, s66, v2
  s_add_u32 s66, s3, 2
  s_and_b32 s66, s66, 3
  s_mul_i32 s66, s66, 57344
  v_add_u32 v5, s66, v2
  s_add_u32 s66, s3, 3
  s_and_b32 s66, s66, 3
  s_mul_i32 s66, s66, 57344
  v_add_u32 v6, s66, v2
  s_mul_i32 s63, s61, 229376
  s_lshl_b32 s66, s3, 10
  s_add_u32 s63, s63, s66
  s_and_b32 s66, s3, 3
  s_mul_i32 s66, s66, 10240
  s_add_u32 s66, s66, 57344
  v_add_u32 v7, s66, v2
  v_mov_b32 v11, 0x20000
  s_mul_i32 s66, s3, 5120
  s_add_u32 s67, s66, 143360
  v_add_u32 v8, s67, v2
  s_lshl_b32 s66, s66, 1
  s_add_u32 s66, s66, 16384
  v_add_u32 v10, s66, v2
  s_lshr_b32 s66, s61, 1
  s_lshl_b32 s66, s66, 10
  s_bfe_u32 s67, s2, 0x30003
  s_lshl_b32 s67, s67, 7
  s_add_u32 s66, s66, s67
  v_mov_b32 v14, s66
  s_waitcnt vmcnt(10)
  s_barrier
  buffer_load_dwordx4 v[196:199], v255, s[48:51], s63 offen sc1
  buffer_load_dwordx4 v[200:203], v4, s[48:51], s63 offen sc1
  buffer_load_dwordx4 v[204:207], v5, s[48:51], s63 offen sc1
  buffer_load_dwordx4 v[208:211], v6, s[48:51], s63 offen sc1
  s_add_u32 s63, s63, 8192
  ds_read_b128 v[136:139], v8 offset:0
  ds_read_b128 v[140:143], v8 offset:1024
  ds_read_b128 v[144:147], v8 offset:2048
  ds_read_b128 v[148:151], v8 offset:3072
  ds_read_b128 v[152:155], v8 offset:4096
  ds_read_b128 v[156:159], v10 offset:0
  ds_read_b128 v[160:163], v10 offset:1024
  ds_read_b128 v[164:167], v10 offset:2048
  ds_read_b128 v[168:171], v10 offset:3072
  ds_read_b128 v[172:175], v10 offset:4096
  ds_read_b128 v[176:179], v10 offset:5120
  ds_read_b128 v[180:183], v10 offset:6144
  ds_read_b128 v[184:187], v10 offset:7168
  ds_read_b128 v[188:191], v10 offset:8192
  ds_read_b128 v[192:195], v10 offset:9216
  s_setprio 3
  buffer_load_dwordx4 v[212:215], v255, s[48:51], s63 offen sc1
  buffer_load_dwordx4 v[216:219], v4, s[48:51], s63 offen sc1
  buffer_load_dwordx4 v[220:223], v5, s[48:51], s63 offen sc1
  buffer_load_dwordx4 v[224:227], v6, s[48:51], s63 offen sc1
  s_add_u32 s63, s63, 8192
  buffer_load_dwordx4 v[228:231], v255, s[48:51], s63 offen sc1
  buffer_load_dwordx4 v[232:235], v4, s[48:51], s63 offen sc1
  buffer_load_dwordx4 v[236:239], v5, s[48:51], s63 offen sc1
  buffer_load_dwordx4 v[240:243], v6, s[48:51], s63 offen sc1
  s_add_u32 s63, s63, 8192
  s_add_u32 s66, s3, 1
  s_and_b32 s66, s66, 3
  s_lshr_b32 s67, s66, 1
  s_lshl_b32 s67, s67, 12
  s_mul_i32 s66, s66, 15360
  s_add_u32 s66, s66, s67
  s_add_u32 s66, s66, 98304
  v_add_u32 v8, s66, v2
  s_add_u32 s66, s3, 2
  s_and_b32 s66, s66, 3
  s_lshr_b32 s67, s66, 1
  s_lshl_b32 s67, s67, 12
  s_mul_i32 s66, s66, 15360
  s_add_u32 s66, s66, s67
  s_add_u32 s66, s66, 103424
  v_add_u32 v10, s66, v2
  s_add_u32 s66, s3, 3
  s_and_b32 s66, s66, 3
  s_lshr_b32 s67, s66, 1
  s_lshl_b32 s67, s67, 12
  s_mul_i32 s66, s66, 15360
  s_add_u32 s66, s66, s67
  s_add_u32 s66, s66, 108544
  v_add_u32 v254, s66, v2
  s_and_b32 s70, s3, 3
  s_mul_i32 s66, s70, 15360
  s_lshr_b32 s67, s70, 1
  s_lshl_b32 s67, s67, 12
  s_add_u32 s66, s66, s67
  s_add_u32 s66, s66, 98304
  v_add_u32 v12, s66, v2
  s_waitcnt vmcnt(8)
  v_mfma_f32_16x16x32_bf16 v[16:19], v[96:99], v[196:199], 0
  v_mfma_f32_16x16x32_bf16 v[36:39], v[96:99], v[200:203], 0
  v_mfma_f32_16x16x32_bf16 v[56:59], v[96:99], v[204:207], 0
  v_mfma_f32_16x16x32_bf16 v[76:79], v[96:99], v[208:211], 0
  v_mfma_f32_16x16x32_bf16 v[20:23], v[100:103], v[196:199], 0
  v_mfma_f32_16x16x32_bf16 v[40:43], v[100:103], v[200:203], 0
  v_mfma_f32_16x16x32_bf16 v[60:63], v[100:103], v[204:207], 0
  v_mfma_f32_16x16x32_bf16 v[80:83], v[100:103], v[208:211], 0
  v_mfma_f32_16x16x32_bf16 v[24:27], v[104:107], v[196:199], 0
  v_mfma_f32_16x16x32_bf16 v[44:47], v[104:107], v[200:203], 0
  v_mfma_f32_16x16x32_bf16 v[64:67], v[104:107], v[204:207], 0
  v_mfma_f32_16x16x32_bf16 v[84:87], v[104:107], v[208:211], 0
  v_mfma_f32_16x16x32_bf16 v[28:31], v[108:111], v[196:199], 0
  v_mfma_f32_16x16x32_bf16 v[48:51], v[108:111], v[200:203], 0
  v_mfma_f32_16x16x32_bf16 v[68:71], v[108:111], v[204:207], 0
  v_mfma_f32_16x16x32_bf16 v[88:91], v[108:111], v[208:211], 0
  v_mfma_f32_16x16x32_bf16 v[32:35], v[112:115], v[196:199], 0
  v_mfma_f32_16x16x32_bf16 v[52:55], v[112:115], v[200:203], 0
  v_mfma_f32_16x16x32_bf16 v[72:75], v[112:115], v[204:207], 0
  v_mfma_f32_16x16x32_bf16 v[92:95], v[112:115], v[208:211], 0
  buffer_load_dwordx4 v[196:199], v255, s[48:51], s63 offen sc1
  buffer_load_dwordx4 v[200:203], v4, s[48:51], s63 offen sc1
  buffer_load_dwordx4 v[204:207], v5, s[48:51], s63 offen sc1
  buffer_load_dwordx4 v[208:211], v6, s[48:51], s63 offen sc1
  s_add_u32 s63, s63, 8192
  ds_read_b128 v[96:99], v7 offset:0
  ds_read_b128 v[100:103], v7 offset:1024
  ds_read_b128 v[104:107], v7 offset:2048
  ds_read_b128 v[108:111], v7 offset:3072
  ds_read_b128 v[112:115], v7 offset:4096
  s_waitcnt vmcnt(8)
  v_mfma_f32_16x16x32_bf16 v[16:19], v[116:119], v[212:215], v[16:19]
  v_mfma_f32_16x16x32_bf16 v[36:39], v[116:119], v[216:219], v[36:39]
  v_mfma_f32_16x16x32_bf16 v[56:59], v[116:119], v[220:223], v[56:59]
  v_mfma_f32_16x16x32_bf16 v[76:79], v[116:119], v[224:227], v[76:79]
  v_mfma_f32_16x16x32_bf16 v[20:23], v[120:123], v[212:215], v[20:23]
  v_mfma_f32_16x16x32_bf16 v[40:43], v[120:123], v[216:219], v[40:43]
  v_mfma_f32_16x16x32_bf16 v[60:63], v[120:123], v[220:223], v[60:63]
  v_mfma_f32_16x16x32_bf16 v[80:83], v[120:123], v[224:227], v[80:83]
  v_mfma_f32_16x16x32_bf16 v[24:27], v[124:127], v[212:215], v[24:27]
  v_mfma_f32_16x16x32_bf16 v[44:47], v[124:127], v[216:219], v[44:47]
  v_mfma_f32_16x16x32_bf16 v[64:67], v[124:127], v[220:223], v[64:67]
  v_mfma_f32_16x16x32_bf16 v[84:87], v[124:127], v[224:227], v[84:87]
  v_mfma_f32_16x16x32_bf16 v[28:31], v[128:131], v[212:215], v[28:31]
  v_mfma_f32_16x16x32_bf16 v[48:51], v[128:131], v[216:219], v[48:51]
  v_mfma_f32_16x16x32_bf16 v[68:71], v[128:131], v[220:223], v[68:71]
  v_mfma_f32_16x16x32_bf16 v[88:91], v[128:131], v[224:227], v[88:91]
  v_mfma_f32_16x16x32_bf16 v[32:35], v[132:135], v[212:215], v[32:35]
  v_mfma_f32_16x16x32_bf16 v[52:55], v[132:135], v[216:219], v[52:55]
  v_mfma_f32_16x16x32_bf16 v[72:75], v[132:135], v[220:223], v[72:75]
  v_mfma_f32_16x16x32_bf16 v[92:95], v[132:135], v[224:227], v[92:95]
  s_cmp_lg_u32 s3, 0
  s_cbranch_scc1 L4_n5
  s_mov_b64 exec, 1
  v_mov_b32 v15, 0
  buffer_atomic_add v15, v14, s[36:39], 0 offen offset:0 sc0 sc1
  s_mov_b64 exec, -1
L4_n5:
  buffer_load_dwordx4 v[212:215], v255, s[48:51], s63 offen sc1
  buffer_load_dwordx4 v[216:219], v4, s[48:51], s63 offen sc1
  buffer_load_dwordx4 v[220:223], v5, s[48:51], s63 offen sc1
  buffer_load_dwordx4 v[224:227], v6, s[48:51], s63 offen sc1
  s_add_u32 s63, s63, 8192
  ds_read_b128 v[116:119], v7 offset:5120
  ds_read_b128 v[120:123], v7 offset:6144
  ds_read_b128 v[124:127], v7 offset:7168
  ds_read_b128 v[128:131], v7 offset:8192
  ds_read_b128 v[132:135], v7 offset:9216
  s_waitcnt vmcnt(8) lgkmcnt(5)
  v_mfma_f32_16x16x32_bf16 v[16:19], v[136:139], v[228:231], v[16:19]
  v_mfma_f32_16x16x32_bf16 v[36:39], v[136:139], v[232:235], v[36:39]
  v_mfma_f32_16x16x32_bf16 v[56:59], v[136:139], v[236:239], v[56:59]
  v_mfma_f32_16x16x32_bf16 v[76:79], v[136:139], v[240:243], v[76:79]
  v_mfma_f32_16x16x32_bf16 v[20:23], v[140:143], v[228:231], v[20:23]
  v_mfma_f32_16x16x32_bf16 v[40:43], v[140:143], v[232:235], v[40:43]
  v_mfma_f32_16x16x32_bf16 v[60:63], v[140:143], v[236:239], v[60:63]
  v_mfma_f32_16x16x32_bf16 v[80:83], v[140:143], v[240:243], v[80:83]
  v_mfma_f32_16x16x32_bf16 v[24:27], v[144:147], v[228:231], v[24:27]
  v_mfma_f32_16x16x32_bf16 v[44:47], v[144:147], v[232:235], v[44:47]
  v_mfma_f32_16x16x32_bf16 v[64:67], v[144:147], v[236:239], v[64:67]
  v_mfma_f32_16x16x32_bf16 v[84:87], v[144:147], v[240:243], v[84:87]
  v_mfma_f32_16x16x32_bf16 v[28:31], v[148:151], v[228:231], v[28:31]
  v_mfma_f32_16x16x32_bf16 v[48:51], v[148:151], v[232:235], v[48:51]
  v_mfma_f32_16x16x32_bf16 v[68:71], v[148:151], v[236:239], v[68:71]
  v_mfma_f32_16x16x32_bf16 v[88:91], v[148:151], v[240:243], v[88:91]
  v_mfma_f32_16x16x32_bf16 v[32:35], v[152:155], v[228:231], v[32:35]
  v_mfma_f32_16x16x32_bf16 v[52:55], v[152:155], v[232:235], v[52:55]
  v_mfma_f32_16x16x32_bf16 v[72:75], v[152:155], v[236:239], v[72:75]
  v_mfma_f32_16x16x32_bf16 v[92:95], v[152:155], v[240:243], v[92:95]
  s_cmp_lg_u32 s3, 0
  s_cbranch_scc1 LP_doneH2
  s_waitcnt vmcnt(4)
  v_cmp_ne_u32 vcc, 32, v15
  s_and_b32 s78, vcc_lo, 1
  s_cbranch_scc0 LP_doneH2x
  s_mov_b64 exec, 1
  v_mov_b32 v15, 0
  buffer_atomic_add v15, v14, s[36:39], 0 offen offset:0 sc0 sc1
  s_mov_b64 exec, -1
  s_mov_b32 s79, 0
LP_loopH2x:
  s_waitcnt vmcnt(0)
  v_cmp_ne_u32 vcc, 32, v15
  s_and_b32 s78, vcc_lo, 1
  s_cbranch_scc0 LP_doneH2x
  s_mov_b64 exec, 1
  v_mov_b32 v15, 0
  buffer_atomic_add v15, v14, s[36:39], 0 offen offset:0 sc0 sc1
  s_mov_b64 exec, -1
  s_add_u32 s79, s79, 1
  s_cmp_lt_u32 s79, 100000
  s_cbranch_scc1 LP_loopH2x
  s_waitcnt vmcnt(0)
LP_doneH2x:
LP_doneH2:
  v_mov_b32 v13, 1
  s_waitcnt lgkmcnt(0)
  s_mov_b64 exec, 1
  ds_add_u32 v11, v13
  s_mov_b64 exec, -1
  s_mov_b32 s79, 0
L4_fl0c:
  ds_read_b32 v13, v11 offset:0
  s_add_u32 s79, s79, 1
  s_waitcnt lgkmcnt(0)
  v_readfirstlane_b32 s78, v13
  s_lshr_b32 s77, s79, 22
  s_add_u32 s78, s78, s77
  s_cmp_lt_u32 s78, 4
  s_cbranch_scc1 L4_fl0c
  buffer_load_dwordx4 v[228:231], v255, s[48:51], s63 offen sc1
  buffer_load_dwordx4 v[232:235], v4, s[48:51], s63 offen sc1
  buffer_load_dwordx4 v[236:239], v5, s[48:51], s63 offen sc1
  buffer_load_dwordx4 v[240:243], v6, s[48:51], s63 offen sc1
  s_add_u32 s63, s63, 8192
  s_waitcnt vmcnt(8)
  v_mfma_f32_16x16x32_bf16 v[16:19], v[156:159], v[196:199], v[16:19]
  v_mfma_f32_16x16x32_bf16 v[36:39], v[156:159], v[200:203], v[36:39]
  v_mfma_f32_16x16x32_bf16 v[56:59], v[156:159], v[204:207], v[56:59]
  v_mfma_f32_16x16x32_bf16 v[76:79], v[156:159], v[208:211], v[76:79]
  v_mfma_f32_16x16x32_bf16 v[20:23], v[160:163], v[196:199], v[20:23]
  v_mfma_f32_16x16x32_bf16 v[40:43], v[160:163], v[200:203], v[40:43]
  v_mfma_f32_16x16x32_bf16 v[60:63], v[160:163], v[204:207], v[60:63]
  v_mfma_f32_16x16x32_bf16 v[80:83], v[160:163], v[208:211], v[80:83]
  v_mfma_f32_16x16x32_bf16 v[24:27], v[164:167], v[196:199], v[24:27]
  v_mfma_f32_16x16x32_bf16 v[44:47], v[164:167], v[200:203], v[44:47]
  v_mfma_f32_16x16x32_bf16 v[64:67], v[164:167], v[204:207], v[64:67]
  v_mfma_f32_16x16x32_bf16 v[84:87], v[164:167], v[208:211], v[84:87]
  v_mfma_f32_16x16x32_bf16 v[28:31], v[168:171], v[196:199], v[28:31]
  v_mfma_f32_16x16x32_bf16 v[48:51], v[168:171], v[200:203], v[48:51]
  v_mfma_f32_16x16x32_bf16 v[68:71], v[168:171], v[204:207], v[68:71]
  v_mfma_f32_16x16x32_bf16 v[88:91], v[168:171], v[208:211], v[88:91]
  v_mfma_f32_16x16x32_bf16 v[32:35], v[172:175], v[196:199], v[32:35]
  v_mfma_f32_16x16x32_bf16 v[52:55], v[172:175], v[200:203], v[52:55]
  v_mfma_f32_16x16x32_bf16 v[72:75], v[172:175], v[204:207], v[72:75]
  v_mfma_f32_16x16x32_bf16 v[92:95], v[172:175], v[208:211], v[92:95]
  buffer_load_dwordx4 v[200:203], v4, s[48:51], s63 offen sc1
  buffer_load_dwordx4 v[204:207], v5, s[48:51], s63 offen sc1
  buffer_load_dwordx4 v[208:211], v6, s[48:51], s63 offen sc1
  buffer_load_dwordx4 v[196:199], v255, s[48:51], s63 offen sc1
  v_and_b32 v13, 15, v1
  v_lshrrev_b32 v1, 4, v1
  v_lshlrev_b32 v13, 4, v13
  v_lshl_add_u32 v14, v1, 15, v13
  v_lshl_add_u32 v15, v1, 14, v13
  s_mul_i32 s66, s60, 327680
  s_lshl_b32 s67, s61, 1
  s_lshr_b32 s68, s3, 1
  s_add_u32 s67, s67, s68
  s_lshl_b32 s67, s67, 8
  s_add_u32 s66, s66, s67
  s_and_b32 s67, s3, 1
  s_lshl_b32 s67, s67, 3
  s_add_u32 s66, s66, s67
  buffer_load_dwordx2 v[244:245], v14, s[40:43], s66 offen sc1
  s_add_u32 s66, s66, 16384
  buffer_load_dwordx2 v[246:247], v14, s[40:43], s66 offen sc1
  s_add_u32 s66, s66, 114688
  buffer_load_dwordx2 v[248:249], v14, s[40:43], s66 offen sc1
  s_add_u32 s66, s66, 16384
  buffer_load_dwordx2 v[250:251], v14, s[40:43], s66 offen sc1
  s_add_u32 s66, s66, 114688
  buffer_load_dwordx2 v[252:253], v15, s[40:43], s66 offen sc1
  s_waitcnt vmcnt(13)
  v_mfma_f32_16x16x32_bf16 v[16:19], v[176:179], v[212:215], v[16:19]
  v_mfma_f32_16x16x32_bf16 v[36:39], v[176:179], v[216:219], v[36:39]
  v_mfma_f32_16x16x32_bf16 v[56:59], v[176:179], v[220:223], v[56:59]
  v_mfma_f32_16x16x32_bf16 v[76:79], v[176:179], v[224:227], v[76:79]
  v_mfma_f32_16x16x32_bf16 v[20:23], v[180:183], v[212:215], v[20:23]
  v_mfma_f32_16x16x32_bf16 v[40:43], v[180:183], v[216:219], v[40:43]
  v_mfma_f32_16x16x32_bf16 v[60:63], v[180:183], v[220:223], v[60:63]
  v_mfma_f32_16x16x32_bf16 v[80:83], v[180:183], v[224:227], v[80:83]
  v_mfma_f32_16x16x32_bf16 v[24:27], v[184:187], v[212:215], v[24:27]
  v_mfma_f32_16x16x32_bf16 v[44:47], v[184:187], v[216:219], v[44:47]
  v_mfma_f32_16x16x32_bf16 v[64:67], v[184:187], v[220:223], v[64:67]
  v_mfma_f32_16x16x32_bf16 v[84:87], v[184:187], v[224:227], v[84:87]
  v_mfma_f32_16x16x32_bf16 v[28:31], v[188:191], v[212:215], v[28:31]
  v_mfma_f32_16x16x32_bf16 v[48:51], v[188:191], v[216:219], v[48:51]
  v_mfma_f32_16x16x32_bf16 v[68:71], v[188:191], v[220:223], v[68:71]
  v_mfma_f32_16x16x32_bf16 v[88:91], v[188:191], v[224:227], v[88:91]
  v_mfma_f32_16x16x32_bf16 v[32:35], v[192:195], v[212:215], v[32:35]
  v_mfma_f32_16x16x32_bf16 v[52:55], v[192:195], v[216:219], v[52:55]
  v_mfma_f32_16x16x32_bf16 v[72:75], v[192:195], v[220:223], v[72:75]
  v_mfma_f32_16x16x32_bf16 v[92:95], v[192:195], v[224:227], v[92:95]
  s_waitcnt vmcnt(9)
  v_mfma_f32_16x16x32_bf16 v[16:19], v[96:99], v[228:231], v[16:19]
  v_mfma_f32_16x16x32_bf16 v[36:39], v[96:99], v[232:235], v[36:39]
  v_mfma_f32_16x16x32_bf16 v[56:59], v[96:99], v[236:239], v[56:59]
  v_mfma_f32_16x16x32_bf16 v[76:79], v[96:99], v[240:243], v[76:79]
  v_mfma_f32_16x16x32_bf16 v[20:23], v[100:103], v[228:231], v[20:23]
  v_mfma_f32_16x16x32_bf16 v[40:43], v[100:103], v[232:235], v[40:43]
  v_mfma_f32_16x16x32_bf16 v[60:63], v[100:103], v[236:239], v[60:63]
  v_mfma_f32_16x16x32_bf16 v[80:83], v[100:103], v[240:243], v[80:83]
  v_mfma_f32_16x16x32_bf16 v[24:27], v[104:107], v[228:231], v[24:27]
  v_mfma_f32_16x16x32_bf16 v[44:47], v[104:107], v[232:235], v[44:47]
  v_mfma_f32_16x16x32_bf16 v[64:67], v[104:107], v[236:239], v[64:67]
  v_mfma_f32_16x16x32_bf16 v[84:87], v[104:107], v[240:243], v[84:87]
  v_mfma_f32_16x16x32_bf16 v[28:31], v[108:111], v[228:231], v[28:31]
  v_mfma_f32_16x16x32_bf16 v[48:51], v[108:111], v[232:235], v[48:51]
  v_mfma_f32_16x16x32_bf16 v[68:71], v[108:111], v[236:239], v[68:71]
  v_mfma_f32_16x16x32_bf16 v[88:91], v[108:111], v[240:243], v[88:91]
  v_mfma_f32_16x16x32_bf16 v[32:35], v[112:115], v[228:231], v[32:35]
  v_mfma_f32_16x16x32_bf16 v[52:55], v[112:115], v[232:235], v[52:55]
  v_mfma_f32_16x16x32_bf16 v[72:75], v[112:115], v[236:239], v[72:75]
  v_mfma_f32_16x16x32_bf16 v[92:95], v[112:115], v[240:243], v[92:95]
  s_waitcnt vmcnt(8)
  v_mfma_f32_16x16x32_bf16 v[36:39], v[116:119], v[200:203], v[36:39]
  v_mfma_f32_16x16x32_bf16 v[40:43], v[120:123], v[200:203], v[40:43]
  v_mfma_f32_16x16x32_bf16 v[44:47], v[124:127], v[200:203], v[44:47]
  v_mfma_f32_16x16x32_bf16 v[48:51], v[128:131], v[200:203], v[48:51]
  v_mfma_f32_16x16x32_bf16 v[52:55], v[132:135], v[200:203], v[52:55]
  s_waitcnt vmcnt(7)
  v_mfma_f32_16x16x32_bf16 v[56:59], v[116:119], v[204:207], v[56:59]
  s_nop 1
  ds_write_b128 v8, v[36:39] offset:0
  v_mfma_f32_16x16x32_bf16 v[60:63], v[120:123], v[204:207], v[60:63]
  ds_write_b128 v8, v[40:43] offset:1024
  v_mfma_f32_16x16x32_bf16 v[64:67], v[124:127], v[204:207], v[64:67]
  ds_write_b128 v8, v[44:47] offset:2048
  v_mfma_f32_16x16x32_bf16 v[68:71], v[128:131], v[204:207], v[68:71]
  ds_write_b128 v8, v[48:51] offset:3072
  v_mfma_f32_16x16x32_bf16 v[72:75], v[132:135], v[204:207], v[72:75]
  ds_write_b128 v8, v[52:55] offset:4096
  s_waitcnt vmcnt(6)
  v_mfma_f32_16x16x32_bf16 v[76:79], v[116:119], v[208:211], v[76:79]
  ds_write_b128 v10, v[56:59] offset:0
  v_mfma_f32_16x16x32_bf16 v[80:83], v[120:123], v[208:211], v[80:83]
  ds_write_b128 v10, v[60:63] offset:1024
  v_mfma_f32_16x16x32_bf16 v[84:87], v[124:127], v[208:211], v[84:87]
  ds_write_b128 v10, v[64:67] offset:2048
  v_mfma_f32_16x16x32_bf16 v[88:91], v[128:131], v[208:211], v[88:91]
  ds_write_b128 v10, v[68:71] offset:3072
  v_mfma_f32_16x16x32_bf16 v[92:95], v[132:135], v[208:211], v[92:95]
  ds_write_b128 v10, v[72:75] offset:4096
  s_waitcnt vmcnt(5)
  v_mfma_f32_16x16x32_bf16 v[16:19], v[116:119], v[196:199], v[16:19]
  ds_write_b128 v254, v[76:79] offset:0
  v_mfma_f32_16x16x32_bf16 v[20:23], v[120:123], v[196:199], v[20:23]
  ds_write_b128 v254, v[80:83] offset:1024
  v_mfma_f32_16x16x32_bf16 v[24:27], v[124:127], v[196:199], v[24:27]
  ds_write_b128 v254, v[84:87] offset:2048
  v_mfma_f32_16x16x32_bf16 v[28:31], v[128:131], v[196:199], v[28:31]
  ds_write_b128 v254, v[88:91] offset:3072
  v_mfma_f32_16x16x32_bf16 v[32:35], v[132:135], v[196:199], v[32:35]
  ds_write_b128 v254, v[92:95] offset:4096
  v_mov_b32 v15, 1
  s_waitcnt lgkmcnt(0)
  s_mov_b64 exec, 1
  ds_add_u32 v11, v15 offset:4
  s_mov_b64 exec, -1
  s_waitcnt vmcnt(0)
  v_lshlrev_b32 v176, 16, v244
  v_and_b32 v177, s82, v244
  v_lshlrev_b32 v178, 16, v245
  v_and_b32 v179, s82, v245
  v_lshlrev_b32 v180, 16, v246
  v_and_b32 v181, s82, v246
  v_lshlrev_b32 v182, 16, v247
  v_and_b32 v183, s82, v247
  v_lshlrev_b32 v184, 16, v248
  v_and_b32 v185, s82, v248
  v_lshlrev_b32 v186, 16, v249
  v_and_b32 v187, s82, v249
  v_lshlrev_b32 v188, 16, v250
  v_and_b32 v189, s82, v250
  v_lshlrev_b32 v190, 16, v251
  v_and_b32 v191, s82, v251
  v_lshlrev_b32 v192, 16, v252
  v_and_b32 v193, s82, v252
  v_lshlrev_b32 v194, 16, v253
  v_and_b32 v195, s82, v253
  v_add_f32 v16, v16, v176
  v_add_f32 v17, v17, v177
  v_add_f32 v18, v18, v178
  v_add_f32 v19, v19, v179
  v_add_f32 v20, v20, v180
  v_add_f32 v21, v21, v181
  v_add_f32 v22, v22, v182
  v_add_f32 v23, v23, v183
  v_add_f32 v24, v24, v184
  v_add_f32 v25, v25, v185
  v_add_f32 v26, v26, v186
  v_add_f32 v27, v27, v187
  v_add_f32 v28, v28, v188
  v_add_f32 v29, v29, v189
  v_add_f32 v30, v30, v190
  v_add_f32 v31, v31, v191
  v_add_f32 v32, v32, v192
  v_add_f32 v33, v33, v193
  v_add_f32 v34, v34, v194
  v_add_f32 v35, v35, v195
  s_mov_b32 s79, 0
L4_fl2:
  ds_read_b32 v13, v11 offset:4
  s_add_u32 s79, s79, 1
  s_waitcnt lgkmcnt(0)
  v_readfirstlane_b32 s78, v13
  s_lshr_b32 s77, s79, 22
  s_add_u32 s78, s78, s77
  s_cmp_lt_u32 s78, 4
  s_cbranch_scc1 L4_fl2
  ds_read_b128 v[96:99], v12 offset:0
  ds_read_b128 v[100:103], v12 offset:5120
  ds_read_b128 v[104:107], v12 offset:10240
  ds_read_b128 v[112:115], v12 offset:1024
  ds_read_b128 v[116:119], v12 offset:6144
  ds_read_b128 v[120:123], v12 offset:11264
  ds_read_b128 v[128:131], v12 offset:2048
  ds_read_b128 v[132:135], v12 offset:7168
  ds_read_b128 v[136:139], v12 offset:12288
  ds_read_b128 v[144:147], v12 offset:3072
  ds_read_b128 v[148:151], v12 offset:8192
  ds_read_b128 v[152:155], v12 offset:13312
  ds_read_b128 v[160:163], v12 offset:4096
  ds_read_b128 v[164:167], v12 offset:9216
  ds_read_b128 v[168:171], v12 offset:14336
  s_waitcnt lgkmcnt(12)
  v_add_f32 v96, v96, v100
  v_add_f32 v97, v97, v101
  v_add_f32 v16, v16, v104
  v_add_f32 v17, v17, v105
  v_add_f32 v16, v16, v96
  v_add_f32 v17, v17, v97
  v_add_f32 v98, v98, v102
  v_add_f32 v99, v99, v103
  v_add_f32 v18, v18, v106
  v_add_f32 v19, v19, v107
  v_add_f32 v18, v18, v98
  v_add_f32 v19, v19, v99
  ds_write_b128 v7, v[16:19] offset:5120
  s_waitcnt lgkmcnt(10)
  v_add_f32 v112, v112, v116
  v_add_f32 v113, v113, v117
  v_add_f32 v20, v20, v120
  v_add_f32 v21, v21, v121
  v_add_f32 v20, v20, v112
  v_add_f32 v21, v21, v113
  v_add_f32 v114, v114, v118
  v_add_f32 v115, v115, v119
  v_add_f32 v22, v22, v122
  v_add_f32 v23, v23, v123
  v_add_f32 v22, v22, v114
  v_add_f32 v23, v23, v115
  ds_write_b128 v7, v[20:23] offset:6144
  s_waitcnt lgkmcnt(8)
  v_add_f32 v128, v128, v132
  v_add_f32 v129, v129, v133
  v_add_f32 v24, v24, v136
  v_add_f32 v25, v25, v137
  v_add_f32 v24, v24, v128
  v_add_f32 v25, v25, v129
  v_add_f32 v130, v130, v134
  v_add_f32 v131, v131, v135
  v_add_f32 v26, v26, v138
  v_add_f32 v27, v27, v139
  v_add_f32 v26, v26, v130
  v_add_f32 v27, v27, v131
  ds_write_b128 v7, v[24:27] offset:7168
  s_waitcnt lgkmcnt(6)
  v_add_f32 v144, v144, v148
  v_add_f32 v145, v145, v149
  v_add_f32 v28, v28, v152
  v_add_f32 v29, v29, v153
  v_add_f32 v28, v28, v144
  v_add_f32 v29, v29, v145
  v_add_f32 v146, v146, v150
  v_add_f32 v147, v147, v151
  v_add_f32 v30, v30, v154
  v_add_f32 v31, v31, v155
  v_add_f32 v30, v30, v146
  v_add_f32 v31, v31, v147
  ds_write_b128 v7, v[28:31] offset:8192
  s_waitcnt lgkmcnt(4)
  v_add_f32 v160, v160, v164
  v_add_f32 v161, v161, v165
  v_add_f32 v32, v32, v168
  v_add_f32 v33, v33, v169
  v_add_f32 v32, v32, v160
  v_add_f32 v33, v33, v161
  v_add_f32 v162, v162, v166
  v_add_f32 v163, v163, v167
  v_add_f32 v34, v34, v170
  v_add_f32 v35, v35, v171
  v_add_f32 v34, v34, v162
  v_add_f32 v35, v35, v163
  ds_write_b128 v7, v[32:35] offset:9216
  s_waitcnt lgkmcnt(0)
  s_barrier
  s_branch LA_fin
L3_help:
  s_sub_u32 s68, s3, 4
  s_lshl_b32 s66, s68, 10
  s_lshl_b32 s68, s68, 4
  s_lshl_b64 s[70:71], 0xffff, s68
  v_add_u32 v4, s34, v2
  s_add_u32 s67, s66, s18
  v_add_u32 v5, 41984, v4
  s_add_u32 s67, s67, 20480
  s_barrier
  s_add_u32 m0, s66, 49152
  s_nop 0
  buffer_load_dwordx4 v4, s[44:47], s67 offen sc1 lds
  s_add_u32 m0, s66, 53248
  s_nop 0
  buffer_load_dwordx4 v5, s[44:47], s67 offen sc1 lds
  s_add_u32 s67, s67, 4096
  s_sub_u32 s68, s67, 40960
  s_min_u32 s67, s67, s68
  s_add_u32 m0, s66, 57344
  s_nop 0
  buffer_load_dwordx4 v4, s[44:47], s67 offen sc1 lds
  s_add_u32 m0, s66, 61440
  s_nop 0
  buffer_load_dwordx4 v5, s[44:47], s67 offen sc1 lds
  s_add_u32 s67, s67, 4096
  s_sub_u32 s68, s67, 40960
  s_min_u32 s67, s67, s68
  s_add_u32 m0, s66, 65536
  s_nop 0
  buffer_load_dwordx4 v4, s[44:47], s67 offen sc1 lds
  s_add_u32 m0, s66, 69632
  s_nop 0
  buffer_load_dwordx4 v5, s[44:47], s67 offen sc1 lds
  s_add_u32 s67, s67, 4096
  s_sub_u32 s68, s67, 40960
  s_min_u32 s67, s67, s68
  s_add_u32 m0, s66, 73728
  s_nop 0
  buffer_load_dwordx4 v4, s[44:47], s67 offen sc1 lds
  s_add_u32 m0, s66, 77824
  s_nop 0
  buffer_load_dwordx4 v5, s[44:47], s67 offen sc1 lds
  s_add_u32 s67, s67, 4096
  s_sub_u32 s68, s67, 40960
  s_min_u32 s67, s67, s68
  s_add_u32 m0, s66, 81920
  s_nop 0
  buffer_load_dwordx4 v4, s[44:47], s67 offen sc1 lds
  s_add_u32 m0, s66, 86016
  s_nop 0
  buffer_load_dwordx4 v5, s[44:47], s67 offen sc1 lds
  s_add_u32 s67, s67, 4096
  s_sub_u32 s68, s67, 40960
  s_min_u32 s67, s67, s68
  s_mov_b32 s68, 40960
  s_mov_b64 exec, s[70:71]
  s_mov_b32 m0, 0
  s_nop 0
  buffer_load_dwordx4 v4, s[44:47], s68 offen sc1 lds
  s_mov_b32 m0, 1024
  s_nop 0
  buffer_load_dwordx4 v5, s[44:47], s68 offen sc1 lds
  s_mov_b64 exec, -1
  v_mov_b32 v4, v5
  v_add_u32 v4, 41984, v4
  s_mov_b32 m0, 2048
  s_mov_b32 s68, 40960
  s_mov_b64 exec, s[70:71]
  buffer_load_dwordx4 v4, s[44:47], s68 offen sc1 lds
  s_mov_b64 exec, -1
  s_add_u32 m0, s66, 90112
  s_nop 0
  buffer_load_dwordx4 v4, s[44:47], s67 offen sc1 lds
  s_add_u32 s67, s67, 4096
  s_sub_u32 s68, s67, 40960
  s_min_u32 s67, s67, s68
  s_add_u32 m0, s66, 94208
  s_nop 0
  buffer_load_dwordx4 v4, s[44:47], s67 offen sc1 lds
  s_add_u32 s67, s67, 4096
  s_sub_u32 s68, s67, 40960
  s_min_u32 s67, s67, s68
  s_add_u32 m0, s66, 98304
  s_nop 0
  buffer_load_dwordx4 v4, s[44:47], s67 offen sc1 lds
  s_add_u32 s67, s67, 4096
  s_sub_u32 s68, s67, 40960
  s_min_u32 s67, s67, s68
  s_add_u32 m0, s66, 102400
  s_nop 0
  buffer_load_dwordx4 v4, s[44:47], s67 offen sc1 lds
  s_add_u32 s67, s67, 4096
  s_sub_u32 s68, s67, 40960
  s_min_u32 s67, s67, s68
  s_add_u32 m0, s66, 106496
  s_nop 0
  buffer_load_dwordx4 v4, s[44:47], s67 offen sc1 lds
  s_add_u32 s67, s67, 4096
  s_sub_u32 s68, s67, 40960
  s_min_u32 s67, s67, s68
  s_add_u32 m0, s66, 110592
  s_nop 0
  buffer_load_dwordx4 v4, s[44:47], s67 offen sc1 lds
  s_add_u32 s67, s67, 4096
  s_sub_u32 s68, s67, 40960
  s_min_u32 s67, s67, s68
  s_add_u32 m0, s66, 114688
  s_nop 0
  buffer_load_dwordx4 v4, s[44:47], s67 offen sc1 lds
  s_add_u32 s67, s67, 4096
  s_sub_u32 s68, s67, 40960
  s_min_u32 s67, s67, s68
  s_add_u32 m0, s66, 118784
  s_nop 0
  buffer_load_dwordx4 v4, s[44:47], s67 offen sc1 lds
  s_add_u32 s67, s67, 4096
  s_sub_u32 s68, s67, 40960
  s_min_u32 s67, s67, s68
  s_add_u32 m0, s66, 122880
  s_nop 0
  buffer_load_dwordx4 v4, s[44:47], s67 offen sc1 lds
  s_add_u32 s67, s67, 4096
  s_sub_u32 s68, s67, 40960
  s_min_u32 s67, s67, s68
  s_add_u32 m0, s66, 126976
  s_nop 0
  buffer_load_dwordx4 v4, s[44:47], s67 offen sc1 lds
  s_add_u32 s67, s67, 4096
  s_sub_u32 s68, s67, 40960
  s_min_u32 s67, s67, s68
  s_waitcnt vmcnt(21)
  s_barrier
  s_cmp_lg_u32 s3, 4
  s_cbranch_scc1 LP_doneW
  s_mov_b64 exec, 65535
  v_mov_b32 v244, 0
  buffer_atomic_add v244, v246, s[36:39], 0 offen offset:12 sc0 sc1
  s_mov_b64 exec, -1
  s_mov_b32 s79, 0
LP_loopW:
  s_waitcnt vmcnt(0)
  v_cmp_ne_u32 vcc, 4102, v244
  s_and_b32 s78, vcc_lo, 65535
  s_cbranch_scc0 LP_doneW
  s_mov_b64 exec, 65535
  v_mov_b32 v244, 0
  buffer_atomic_add v244, v246, s[36:39], 0 offen offset:12 sc0 sc1
  s_mov_b64 exec, -1
  s_add_u32 s79, s79, 1
  s_cmp_lt_u32 s79, 100000
  s_cbranch_scc1 LP_loopW
  s_waitcnt vmcnt(0)
LP_doneW:
  s_waitcnt vmcnt(11)
  s_barrier
  v_add_u32 v4, 41984, v4
  s_mov_b32 m0, 3072
  s_mov_b32 s68, 40960
  s_mov_b64 exec, s[70:71]
  buffer_load_dwordx4 v4, s[44:47], s68 offen sc1 lds
  s_mov_b64 exec, -1
  s_add_u32 m0, s66, 131072
  s_nop 0
  buffer_load_dwordx4 v4, s[44:47], s67 offen sc1 lds
  s_add_u32 s67, s67, 4096
  s_sub_u32 s68, s67, 40960
  s_min_u32 s67, s67, s68
  s_add_u32 m0, s66, 135168
  s_nop 0
  buffer_load_dwordx4 v4, s[44:47], s67 offen sc1 lds
  s_add_u32 s67, s67, 4096
  s_sub_u32 s68, s67, 40960
  s_min_u32 s67, s67, s68
  s_add_u32 m0, s66, 139264
  s_nop 0
  buffer_load_dwordx4 v4, s[44:47], s67 offen sc1 lds
  s_add_u32 s67, s67, 4096
  s_sub_u32 s68, s67, 40960
  s_min_u32 s67, s67, s68
  s_add_u32 m0, s66, 143360
  s_nop 0
  buffer_load_dwordx4 v4, s[44:47], s67 offen sc1 lds
  s_add_u32 s67, s67, 4096
  s_sub_u32 s68, s67, 40960
  s_min_u32 s67, s67, s68
  s_add_u32 m0, s66, 147456
  s_nop 0
  buffer_load_dwordx4 v4, s[44:47], s67 offen sc1 lds
  s_add_u32 s67, s67, 4096
  s_sub_u32 s68, s67, 40960
  s_min_u32 s67, s67, s68
  s_add_u32 m0, s66, 151552
  s_nop 0
  buffer_load_dwordx4 v4, s[44:47], s67 offen sc1 lds
  s_add_u32 s67, s67, 4096
  s_sub_u32 s68, s67, 40960
  s_min_u32 s67, s67, s68
  s_add_u32 m0, s66, 155648
  s_nop 0
  buffer_load_dwordx4 v4, s[44:47], s67 offen sc1 lds
  s_add_u32 s67, s67, 4096
  s_sub_u32 s68, s67, 40960
  s_min_u32 s67, s67, s68
  s_add_u32 m0, s66, 159744
  s_nop 0
  buffer_load_dwordx4 v4, s[44:47], s67 offen sc1 lds
  s_add_u32 s67, s67, 4096
  s_sub_u32 s68, s67, 40960
  s_min_u32 s67, s67, s68
  s_add_u32 m0, s66, 8192
  s_nop 0
  buffer_load_dwordx4 v4, s[44:47], s67 offen sc1 lds
  s_add_u32 s67, s67, 4096
  s_sub_u32 s68, s67, 40960
  s_min_u32 s67, s67, s68
  s_add_u32 m0, s66, 12288
  s_nop 0
  buffer_load_dwordx4 v4, s[44:47], s67 offen sc1 lds
  s_add_u32 s67, s67, 4096
  s_sub_u32 s68, s67, 40960
  s_min_u32 s67, s67, s68
  v_add_u32 v4, 41984, v4
  s_mov_b32 m0, 4096
  s_mov_b32 s68, 40960
  s_mov_b64 exec, s[70:71]
  buffer_load_dwordx4 v4, s[44:47], s68 offen sc1 lds
  s_mov_b64 exec, -1
  s_add_u32 m0, s66, 16384
  s_nop 0
  buffer_load_dwordx4 v4, s[44:47], s67 offen sc1 lds
  s_add_u32 s67, s67, 4096
  s_sub_u32 s68, s67, 40960
  s_min_u32 s67, s67, s68
  s_add_u32 m0, s66, 20480
  s_nop 0
  buffer_load_dwordx4 v4, s[44:47], s67 offen sc1 lds
  s_add_u32 s67, s67, 4096
  s_sub_u32 s68, s67, 40960
  s_min_u32 s67, s67, s68
  s_add_u32 m0, s66, 24576
  s_nop 0
  buffer_load_dwordx4 v4, s[44:47], s67 offen sc1 lds
  s_add_u32 s67, s67, 4096
  s_sub_u32 s68, s67, 40960
  s_min_u32 s67, s67, s68
  s_add_u32 m0, s66, 28672
  s_nop 0
  buffer_load_dwordx4 v4, s[44:47], s67 offen sc1 lds
  s_add_u32 s67, s67, 4096
  s_sub_u32 s68, s67, 40960
  s_min_u32 s67, s67, s68
  s_add_u32 m0, s66, 32768
  s_nop 0
  buffer_load_dwordx4 v4, s[44:47], s67 offen sc1 lds
  s_add_u32 s67, s67, 4096
  s_sub_u32 s68, s67, 40960
  s_min_u32 s67, s67, s68
  s_add_u32 m0, s66, 36864
  s_nop 0
  buffer_load_dwordx4 v4, s[44:47], s67 offen sc1 lds
  s_add_u32 s67, s67, 4096
  s_sub_u32 s68, s67, 40960
  s_min_u32 s67, s67, s68
  s_add_u32 m0, s66, 40960
  s_nop 0
  buffer_load_dwordx4 v4, s[44:47], s67 offen sc1 lds
  s_add_u32 s67, s67, 4096
  s_sub_u32 s68, s67, 40960
  s_min_u32 s67, s67, s68
  s_add_u32 m0, s66, 45056
  s_nop 0
  buffer_load_dwordx4 v4, s[44:47], s67 offen sc1 lds
  s_add_u32 s67, s67, 4096
  s_sub_u32 s68, s67, 40960
  s_min_u32 s67, s67, s68
  s_add_u32 m0, s66, 49152
  s_nop 0
  buffer_load_dwordx4 v4, s[44:47], s67 offen sc1 lds
  s_add_u32 s67, s67, 4096
  s_sub_u32 s68, s67, 40960
  s_min_u32 s67, s67, s68
  s_add_u32 m0, s66, 53248
  s_nop 0
  buffer_load_dwordx4 v4, s[44:47], s67 offen sc1 lds
  s_add_u32 s67, s67, 4096
  s_sub_u32 s68, s67, 40960
  s_min_u32 s67, s67, s68
  s_waitcnt vmcnt(22)
  s_barrier
  v_add_u32 v4, 41984, v4
  s_mov_b32 m0, 5120
  s_mov_b32 s68, 40960
  s_mov_b64 exec, s[70:71]
  buffer_load_dwordx4 v4, s[44:47], s68 offen sc1 lds
  s_mov_b64 exec, -1
  s_add_u32 m0, s66, 57344
  s_nop 0
  buffer_load_dwordx4 v4, s[44:47], s67 offen sc1 lds
  s_add_u32 s67, s67, 4096
  s_sub_u32 s68, s67, 40960
  s_min_u32 s67, s67, s68
  s_add_u32 m0, s66, 61440
  s_nop 0
  buffer_load_dwordx4 v4, s[44:47], s67 offen sc1 lds
  s_add_u32 s67, s67, 4096
  s_sub_u32 s68, s67, 40960
  s_min_u32 s67, s67, s68
  s_add_u32 m0, s66, 65536
  s_nop 0
  buffer_load_dwordx4 v4, s[44:47], s67 offen sc1 lds
  s_add_u32 s67, s67, 4096
  s_sub_u32 s68, s67, 40960
  s_min_u32 s67, s67, s68
  s_add_u32 m0, s66, 69632
  s_nop 0
  buffer_load_dwordx4 v4, s[44:47], s67 offen sc1 lds
  s_add_u32 s67, s67, 4096
  s_sub_u32 s68, s67, 40960
  s_min_u32 s67, s67, s68
  s_add_u32 m0, s66, 73728
  s_nop 0
  buffer_load_dwordx4 v4, s[44:47], s67 offen sc1 lds
  s_add_u32 s67, s67, 4096
  s_sub_u32 s68, s67, 40960
  s_min_u32 s67, s67, s68
  s_add_u32 m0, s66, 77824
  s_nop 0
  buffer_load_dwordx4 v4, s[44:47], s67 offen sc1 lds
  s_add_u32 s67, s67, 4096
  s_sub_u32 s68, s67, 40960
  s_min_u32 s67, s67, s68
  s_add_u32 m0, s66, 81920
  s_nop 0
  buffer_load_dwordx4 v4, s[44:47], s67 offen sc1 lds
  s_add_u32 s67, s67, 4096
  s_sub_u32 s68, s67, 40960
  s_min_u32 s67, s67, s68
  s_add_u32 m0, s66, 86016
  s_nop 0
  buffer_load_dwordx4 v4, s[44:47], s67 offen sc1 lds
  s_add_u32 s67, s67, 4096
  s_sub_u32 s68, s67, 40960
  s_min_u32 s67, s67, s68
  buffer_load_dwordx4 v[96:99], v2, s[52:55], s62 offen offset:0 sc1
  buffer_load_dwordx4 v[100:103], v2, s[52:55], s62 offen offset:1024 sc1
  buffer_load_dwordx4 v[104:107], v2, s[52:55], s62 offen offset:2048 sc1
  buffer_load_dwordx4 v[108:111], v2, s[52:55], s62 offen offset:3072 sc1
  buffer_load_dwordx4 v[112:115], v3, s[52:55], s62 offen offset:0 sc1
  s_add_u32 s62, s62, 40960
  s_waitcnt vmcnt(25)
  s_barrier
  s_add_u32 m0, s66, 90112
  s_nop 0
  buffer_load_dwordx4 v4, s[44:47], s67 offen sc1 lds
  s_add_u32 s67, s67, 4096
  s_sub_u32 s68, s67, 40960
  s_min_u32 s67, s67, s68
  s_add_u32 m0, s66, 94208
  s_nop 0
  buffer_load_dwordx4 v4, s[44:47], s67 offen sc1 lds
  s_add_u32 s67, s67, 4096
  s_sub_u32 s68, s67, 40960
  s_min_u32 s67, s67, s68
  v_add_u32 v4, 41984, v4
  s_mov_b32 m0, 6144
  s_mov_b32 s68, 40960
  s_mov_b64 exec, s[70:71]
  buffer_load_dwordx4 v4, s[44:47], s68 offen sc1 lds
  s_mov_b64 exec, -1
  s_add_u32 m0, s66, 98304
  s_nop 0
  buffer_load_dwordx4 v4, s[44:47], s67 offen sc1 lds
  s_add_u32 s67, s67, 4096
  s_sub_u32 s68, s67, 40960
  s_min_u32 s67, s67, s68
  s_add_u32 m0, s66, 102400
  s_nop 0
  buffer_load_dwordx4 v4, s[44:47], s67 offen sc1 lds
  s_add_u32 s67, s67, 4096
  s_sub_u32 s68, s67, 40960
  s_min_u32 s67, s67, s68
  s_add_u32 m0, s66, 106496
  s_nop 0
  buffer_load_dwordx4 v4, s[44:47], s67 offen sc1 lds
  s_add_u32 s67, s67, 4096
  s_sub_u32 s68, s67, 40960
  s_min_u32 s67, s67, s68
  s_add_u32 m0, s66, 110592
  s_nop 0
  buffer_load_dwordx4 v4, s[44:47], s67 offen sc1 lds
  s_add_u32 s67, s67, 4096
  s_sub_u32 s68, s67, 40960
  s_min_u32 s67, s67, s68
  s_add_u32 m0, s66, 114688
  s_nop 0
  buffer_load_dwordx4 v4, s[44:47], s67 offen sc1 lds
  s_add_u32 s67, s67, 4096
  s_sub_u32 s68, s67, 40960
  s_min_u32 s67, s67, s68
  s_add_u32 m0, s66, 118784
  s_nop 0
  buffer_load_dwordx4 v4, s[44:47], s67 offen sc1 lds
  s_add_u32 s67, s67, 4096
  s_sub_u32 s68, s67, 40960
  s_min_u32 s67, s67, s68
  s_add_u32 m0, s66, 122880
  s_nop 0
  buffer_load_dwordx4 v4, s[44:47], s67 offen sc1 lds
  s_add_u32 s67, s67, 4096
  s_sub_u32 s68, s67, 40960
  s_min_u32 s67, s67, s68
  s_add_u32 m0, s66, 126976
  s_nop 0
  buffer_load_dwordx4 v4, s[44:47], s67 offen sc1 lds
  s_add_u32 s67, s67, 4096
  s_sub_u32 s68, s67, 40960
  s_min_u32 s67, s67, s68
  buffer_load_dwordx4 v[116:119], v2, s[52:55], s62 offen offset:0 sc1
  buffer_load_dwordx4 v[120:123], v2, s[52:55], s62 offen offset:1024 sc1
  buffer_load_dwordx4 v[124:127], v2, s[52:55], s62 offen offset:2048 sc1
  s_waitcnt vmcnt(28)
  s_barrier
  s_add_u32 m0, s66, 8192
  s_nop 0
  buffer_load_dwordx4 v4, s[44:47], s67 offen sc1 lds
  s_add_u32 s67, s67, 4096
  s_sub_u32 s68, s67, 40960
  s_min_u32 s67, s67, s68
  s_add_u32 m0, s66, 12288
  s_nop 0
  buffer_load_dwordx4 v4, s[44:47], s67 offen sc1 lds
  s_add_u32 s67, s67, 4096
  s_sub_u32 s68, s67, 40960
  s_min_u32 s67, s67, s68
  s_sub_u32 s68, s3, 4
  s_mul_i32 s69, s68, 5120
  s_add_u32 m0, s69, 143360
  s_mul_i32 s69, s60, 56
  s_add_u32 s68, s68, s69
  s_mul_i32 s68, s68, 5120
  s_add_u32 s68, s68, 81920
  buffer_load_dwordx4 v2, s[52:55], s68 offen offset:0 sc1 lds
  buffer_load_dwordx4 v2, s[52:55], s68 offen offset:1024 sc1 lds
  buffer_load_dwordx4 v2, s[52:55], s68 offen offset:2048 sc1 lds
  buffer_load_dwordx4 v2, s[52:55], s68 offen offset:3072 sc1 lds
  s_add_u32 s68, s68, 4096
  s_add_u32 m0, m0, 4096
  s_nop 0
  buffer_load_dwordx4 v2, s[52:55], s68 offen offset:0 sc1 lds
  buffer_load_dwordx4 v[128:131], v2, s[52:55], s62 offen offset:3072 sc1
  buffer_load_dwordx4 v[132:135], v3, s[52:55], s62 offen offset:0 sc1
  s_add_u32 s62, s62, 40960
  buffer_load_dwordx4 v[136:139], v2, s[52:55], s62 offen offset:0 sc1
  buffer_load_dwordx4 v[140:143], v2, s[52:55], s62 offen offset:1024 sc1
  buffer_load_dwordx4 v[144:147], v2, s[52:55], s62 offen offset:2048 sc1
  buffer_load_dwordx4 v[148:151], v2, s[52:55], s62 offen offset:3072 sc1
  buffer_load_dwordx4 v[152:155], v3, s[52:55], s62 offen offset:0 sc1
  s_add_u32 s62, s62, 40960
  s_waitcnt vmcnt(26)
  s_barrier
  s_sub_u32 s68, s3, 4
  s_mul_i32 s69, s68, 10240
  s_add_u32 m0, s69, 16384
  s_mul_i32 s69, s60, 56
  s_add_u32 s68, s68, s69
  s_mul_i32 s68, s68, 5120
  s_add_u32 s68, s68, 122880
  buffer_load_dwordx4 v2, s[52:55], s68 offen offset:0 sc1 lds
  buffer_load_dwordx4 v2, s[52:55], s68 offen offset:1024 sc1 lds
  buffer_load_dwordx4 v2, s[52:55], s68 offen offset:2048 sc1 lds
  buffer_load_dwordx4 v2, s[52:55], s68 offen offset:3072 sc1 lds
  s_add_u32 s68, s68, 4096
  s_add_u32 m0, m0, 4096
  s_nop 0
  buffer_load_dwordx4 v2, s[52:55], s68 offen offset:0 sc1 lds
  s_add_u32 s68, s68, 36864
  s_add_u32 m0, m0, 1024
  s_nop 0
  buffer_load_dwordx4 v2, s[52:55], s68 offen offset:0 sc1 lds
  buffer_load_dwordx4 v2, s[52:55], s68 offen offset:1024 sc1 lds
  buffer_load_dwordx4 v2, s[52:55], s68 offen offset:2048 sc1 lds
  buffer_load_dwordx4 v2, s[52:55], s68 offen offset:3072 sc1 lds
  s_add_u32 s68, s68, 4096
  s_add_u32 m0, m0, 4096
  s_nop 0
  buffer_load_dwordx4 v2, s[52:55], s68 offen offset:0 sc1 lds
  buffer_load_dwordx4 v[156:159], v2, s[52:55], s62 offen offset:0 sc1
  buffer_load_dwordx4 v[160:163], v2, s[52:55], s62 offen offset:1024 sc1
  buffer_load_dwordx4 v[164:167], v2, s[52:55], s62 offen offset:2048 sc1
  buffer_load_dwordx4 v[168:171], v2, s[52:55], s62 offen offset:3072 sc1
  buffer_load_dwordx4 v[172:175], v3, s[52:55], s62 offen offset:0 sc1
  s_add_u32 s62, s62, 40960
  v_lshlrev_b32 v12, 7, v1
  v_mov_b32 v13, 1
  s_lshr_b32 s68, s61, 1
  s_lshl_b32 s68, s68, 10
  s_bfe_u32 s69, s2, 0x30003
  s_lshl_b32 s69, s69, 7
  s_add_u32 s68, s68, s69
  v_mov_b32 v14, s68
  s_waitcnt vmcnt(27)
  s_barrier
  s_barrier
  s_cmp_lg_u32 s3, 4
  s_cbranch_scc1 L3_n4
  s_and_b32 s78, s32, 15
  s_lshl_b32 s78, s78, 10
  s_mov_b64 exec, 255
  buffer_atomic_add v13, v12, s[36:39], s78 offen offset:8 sc1
  s_mov_b64 exec, -1
L3_n4:
  buffer_load_dwordx4 v[176:179], v2, s[52:55], s62 offen offset:0 sc1
  buffer_load_dwordx4 v[180:183], v2, s[52:55], s62 offen offset:1024 sc1
  buffer_load_dwordx4 v[184:187], v2, s[52:55], s62 offen offset:2048 sc1
  buffer_load_dwordx4 v[188:191], v2, s[52:55], s62 offen offset:3072 sc1
  buffer_load_dwordx4 v[192:195], v3, s[52:55], s62 offen offset:0 sc1
  s_sub_u32 s68, s3, 4
  s_mul_i32 s69, s68, 10240
  s_add_u32 m0, s69, 57344
  s_mul_i32 s69, s60, 56
  s_add_u32 s68, s68, s69
  s_mul_i32 s68, s68, 5120
  s_add_u32 s68, s68, 204800
  buffer_load_dwordx4 v2, s[52:55], s68 offen offset:0 sc1 lds
  buffer_load_dwordx4 v2, s[52:55], s68 offen offset:1024 sc1 lds
  buffer_load_dwordx4 v2, s[52:55], s68 offen offset:2048 sc1 lds
  buffer_load_dwordx4 v2, s[52:55], s68 offen offset:3072 sc1 lds
  s_add_u32 s68, s68, 4096
  s_add_u32 m0, m0, 4096
  s_nop 0
  buffer_load_dwordx4 v2, s[52:55], s68 offen offset:0 sc1 lds
  s_add_u32 s68, s68, 36864
  s_add_u32 m0, m0, 1024
  s_nop 0
  buffer_load_dwordx4 v2, s[52:55], s68 offen offset:0 sc1 lds
  buffer_load_dwordx4 v2, s[52:55], s68 offen offset:1024 sc1 lds
  buffer_load_dwordx4 v2, s[52:55], s68 offen offset:2048 sc1 lds
  buffer_load_dwordx4 v2, s[52:55], s68 offen offset:3072 sc1 lds
  s_add_u32 s68, s68, 4096
  s_add_u32 m0, m0, 4096
  s_nop 0
  buffer_load_dwordx4 v2, s[52:55], s68 offen offset:0 sc1 lds
  s_add_u32 s66, s3, 0
  s_and_b32 s66, s66, 3
  s_mul_i32 s66, s66, 57344
  v_add_u32 v255, s66, v2
  s_add_u32 s66, s3, 1
  s_and_b32 s66, s66, 3
  s_mul_i32 s66, s66, 57344
  v_add_u32 v4, s66, v2
  s_add_u32 s66, s3, 2
  s_and_b32 s66, s66, 3
  s_mul_i32 s66, s66, 57344
  v_add_u32 v5, s66, v2
  s_add_u32 s66, s3, 3
  s_and_b32 s66, s66, 3
  s_mul_i32 s66, s66, 57344
  v_add_u32 v6, s66, v2
  s_mul_i32 s63, s61, 229376
  s_lshl_b32 s66, s3, 10
  s_add_u32 s63, s63, s66
  s_and_b32 s66, s3, 3
  s_mul_i32 s66, s66, 10240
  s_add_u32 s66, s66, 57344
  v_add_u32 v7, s66, v2
  v_mov_b32 v11, 0x20000
  v_mov_b32 v16, 0
  v_mov_b32 v17, 0
  ds_write_b64 v11, v[16:17]
  s_cmp_lg_u32 s3, 4
  s_cbranch_scc1 LP_doneE
  s_mov_b64 exec, 1
  v_mov_b32 v15, 0
  buffer_atomic_add v15, v14, s[36:39], 0 offen offset:8 sc0 sc1
  s_mov_b64 exec, -1
  s_mov_b32 s79, 0
LP_loopE:
  s_waitcnt vmcnt(0)
  v_cmp_ne_u32 vcc, 22, v15
  s_and_b32 s78, vcc_lo, 1
  s_cbranch_scc0 LP_doneE
  s_mov_b64 exec, 1
  v_mov_b32 v15, 0
  buffer_atomic_add v15, v14, s[36:39], 0 offen offset:8 sc0 sc1
  s_mov_b64 exec, -1
  s_add_u32 s79, s79, 1
  s_cmp_lt_u32 s79, 100000
  s_cbranch_scc1 LP_loopE
  s_waitcnt vmcnt(0)
LP_doneE:
  s_waitcnt vmcnt(0) lgkmcnt(0)
  s_barrier
  s_cmp_lg_u32 s3, 4
  s_cbranch_scc1 L4_n4
  s_and_b32 s78, s32, 15
  s_lshl_b32 s78, s78, 10
  s_mov_b64 exec, 255
  buffer_atomic_add v13, v12, s[36:39], s78 offen offset:0 sc1
  s_mov_b64 exec, -1
L4_n4:
  buffer_load_dwordx4 v[196:199], v255, s[48:51], s63 offen sc1
  buffer_load_dwordx4 v[200:203], v4, s[48:51], s63 offen sc1
  buffer_load_dwordx4 v[204:207], v5, s[48:51], s63 offen sc1
  buffer_load_dwordx4 v[208:211], v6, s[48:51], s63 offen sc1
  s_add_u32 s63, s63, 8192
  buffer_load_dwordx4 v[212:215], v255, s[48:51], s63 offen sc1
  buffer_load_dwordx4 v[216:219], v4, s[48:51], s63 offen sc1
  buffer_load_dwordx4 v[220:223], v5, s[48:51], s63 offen sc1
  buffer_load_dwordx4 v[224:227], v6, s[48:51], s63 offen sc1
  s_add_u32 s63, s63, 8192
  s_add_u32 s66, s3, 1
  s_and_b32 s66, s66, 3
  s_mul_i32 s66, s66, 15360
  s_add_u32 s66, s66, 0
  v_add_u32 v8, s66, v2
  s_add_u32 s66, s3, 2
  s_and_b32 s66, s66, 3
  s_mul_i32 s66, s66, 15360
  s_add_u32 s66, s66, 5120
  v_add_u32 v10, s66, v2
  s_add_u32 s66, s3, 3
  s_and_b32 s66, s66, 3
  s_mul_i32 s66, s66, 15360
  s_add_u32 s66, s66, 10240
  v_add_u32 v254, s66, v2
  s_and_b32 s70, s3, 3
  s_mul_i32 s66, s70, 15360
  v_add_u32 v12, s66, v2
  s_waitcnt vmcnt(4)
  v_mfma_f32_16x16x32_bf16 v[16:19], v[96:99], v[196:199], 0
  v_mfma_f32_16x16x32_bf16 v[36:39], v[96:99], v[200:203], 0
  v_mfma_f32_16x16x32_bf16 v[56:59], v[96:99], v[204:207], 0
  v_mfma_f32_16x16x32_bf16 v[76:79], v[96:99], v[208:211], 0
  v_mfma_f32_16x16x32_bf16 v[20:23], v[100:103], v[196:199], 0
  v_mfma_f32_16x16x32_bf16 v[40:43], v[100:103], v[200:203], 0
  v_mfma_f32_16x16x32_bf16 v[60:63], v[100:103], v[204:207], 0
  v_mfma_f32_16x16x32_bf16 v[80:83], v[100:103], v[208:211], 0
  v_mfma_f32_16x16x32_bf16 v[24:27], v[104:107], v[196:199], 0
  v_mfma_f32_16x16x32_bf16 v[44:47], v[104:107], v[200:203], 0
  v_mfma_f32_16x16x32_bf16 v[64:67], v[104:107], v[204:207], 0
  v_mfma_f32_16x16x32_bf16 v[84:87], v[104:107], v[208:211], 0
  v_mfma_f32_16x16x32_bf16 v[28:31], v[108:111], v[196:199], 0
  v_mfma_f32_16x16x32_bf16 v[48:51], v[108:111], v[200:203], 0
  v_mfma_f32_16x16x32_bf16 v[68:71], v[108:111], v[204:207], 0
  v_mfma_f32_16x16x32_bf16 v[88:91], v[108:111], v[208:211], 0
  v_mfma_f32_16x16x32_bf16 v[32:35], v[112:115], v[196:199], 0
  v_mfma_f32_16x16x32_bf16 v[52:55], v[112:115], v[200:203], 0
  v_mfma_f32_16x16x32_bf16 v[72:75], v[112:115], v[204:207], 0
  v_mfma_f32_16x16x32_bf16 v[92:95], v[112:115], v[208:211], 0
  buffer_load_dwordx4 v[228:231], v255, s[48:51], s63 offen sc1
  buffer_load_dwordx4 v[232:235], v4, s[48:51], s63 offen sc1
  buffer_load_dwordx4 v[236:239], v5, s[48:51], s63 offen sc1
  buffer_load_dwordx4 v[240:243], v6, s[48:51], s63 offen sc1
  s_add_u32 s63, s63, 8192
  buffer_load_dwordx4 v[196:199], v255, s[48:51], s63 offen sc1
  buffer_load_dwordx4 v[200:203], v4, s[48:51], s63 offen sc1
  buffer_load_dwordx4 v[204:207], v5, s[48:51], s63 offen sc1
  buffer_load_dwordx4 v[208:211], v6, s[48:51], s63 offen sc1
  s_add_u32 s63, s63, 8192
  s_waitcnt vmcnt(8)
  v_mfma_f32_16x16x32_bf16 v[16:19], v[116:119], v[212:215], v[16:19]
  v_mfma_f32_16x16x32_bf16 v[36:39], v[116:119], v[216:219], v[36:39]
  v_mfma_f32_16x16x32_bf16 v[56:59], v[116:119], v[220:223], v[56:59]
  v_mfma_f32_16x16x32_bf16 v[76:79], v[116:119], v[224:227], v[76:79]
  v_mfma_f32_16x16x32_bf16 v[20:23], v[120:123], v[212:215], v[20:23]
  v_mfma_f32_16x16x32_bf16 v[40:43], v[120:123], v[216:219], v[40:43]
  v_mfma_f32_16x16x32_bf16 v[60:63], v[120:123], v[220:223], v[60:63]
  v_mfma_f32_16x16x32_bf16 v[80:83], v[120:123], v[224:227], v[80:83]
  v_mfma_f32_16x16x32_bf16 v[24:27], v[124:127], v[212:215], v[24:27]
  v_mfma_f32_16x16x32_bf16 v[44:47], v[124:127], v[216:219], v[44:47]
  v_mfma_f32_16x16x32_bf16 v[64:67], v[124:127], v[220:223], v[64:67]
  v_mfma_f32_16x16x32_bf16 v[84:87], v[124:127], v[224:227], v[84:87]
  v_mfma_f32_16x16x32_bf16 v[28:31], v[128:131], v[212:215], v[28:31]
  v_mfma_f32_16x16x32_bf16 v[48:51], v[128:131], v[216:219], v[48:51]
  v_mfma_f32_16x16x32_bf16 v[68:71], v[128:131], v[220:223], v[68:71]
  v_mfma_f32_16x16x32_bf16 v[88:91], v[128:131], v[224:227], v[88:91]
  v_mfma_f32_16x16x32_bf16 v[32:35], v[132:135], v[212:215], v[32:35]
  v_mfma_f32_16x16x32_bf16 v[52:55], v[132:135], v[216:219], v[52:55]
  v_mfma_f32_16x16x32_bf16 v[72:75], v[132:135], v[220:223], v[72:75]
  v_mfma_f32_16x16x32_bf16 v[92:95], v[132:135], v[224:227], v[92:95]
  buffer_load_dwordx4 v[212:215], v255, s[48:51], s63 offen sc1
  buffer_load_dwordx4 v[216:219], v4, s[48:51], s63 offen sc1
  buffer_load_dwordx4 v[220:223], v5, s[48:51], s63 offen sc1
  buffer_load_dwordx4 v[224:227], v6, s[48:51], s63 offen sc1
  s_add_u32 s63, s63, 8192
  s_waitcnt vmcnt(8)
  v_mfma_f32_16x16x32_bf16 v[16:19], v[136:139], v[228:231], v[16:19]
  v_mfma_f32_16x16x32_bf16 v[36:39], v[136:139], v[232:235], v[36:39]
  v_mfma_f32_16x16x32_bf16 v[56:59], v[136:139], v[236:239], v[56:59]
  v_mfma_f32_16x16x32_bf16 v[76:79], v[136:139], v[240:243], v[76:79]
  v_mfma_f32_16x16x32_bf16 v[20:23], v[140:143], v[228:231], v[20:23]
  v_mfma_f32_16x16x32_bf16 v[40:43], v[140:143], v[232:235], v[40:43]
  v_mfma_f32_16x16x32_bf16 v[60:63], v[140:143], v[236:239], v[60:63]
  v_mfma_f32_16x16x32_bf16 v[80:83], v[140:143], v[240:243], v[80:83]
  v_mfma_f32_16x16x32_bf16 v[24:27], v[144:147], v[228:231], v[24:27]
  v_mfma_f32_16x16x32_bf16 v[44:47], v[144:147], v[232:235], v[44:47]
  v_mfma_f32_16x16x32_bf16 v[64:67], v[144:147], v[236:239], v[64:67]
  v_mfma_f32_16x16x32_bf16 v[84:87], v[144:147], v[240:243], v[84:87]
  v_mfma_f32_16x16x32_bf16 v[28:31], v[148:151], v[228:231], v[28:31]
  v_mfma_f32_16x16x32_bf16 v[48:51], v[148:151], v[232:235], v[48:51]
  v_mfma_f32_16x16x32_bf16 v[68:71], v[148:151], v[236:239], v[68:71]
  v_mfma_f32_16x16x32_bf16 v[88:91], v[148:151], v[240:243], v[88:91]
  v_mfma_f32_16x16x32_bf16 v[32:35], v[152:155], v[228:231], v[32:35]
  v_mfma_f32_16x16x32_bf16 v[52:55], v[152:155], v[232:235], v[52:55]
  v_mfma_f32_16x16x32_bf16 v[72:75], v[152:155], v[236:239], v[72:75]
  v_mfma_f32_16x16x32_bf16 v[92:95], v[152:155], v[240:243], v[92:95]
  s_mov_b32 s79, 0
L4_fl0h:
  ds_read_b32 v13, v11 offset:0
  s_add_u32 s79, s79, 1
  s_waitcnt lgkmcnt(0)
  v_readfirstlane_b32 s78, v13
  s_lshr_b32 s77, s79, 22
  s_add_u32 s78, s78, s77
  s_cmp_lt_u32 s78, 4
  s_cbranch_scc1 L4_fl0h
  buffer_load_dwordx4 v[228:231], v255, s[48:51], s63 offen sc1
  buffer_load_dwordx4 v[232:235], v4, s[48:51], s63 offen sc1
  buffer_load_dwordx4 v[236:239], v5, s[48:51], s63 offen sc1
  buffer_load_dwordx4 v[240:243], v6, s[48:51], s63 offen sc1
  s_add_u32 s63, s63, 8192
  s_waitcnt vmcnt(8)
  v_mfma_f32_16x16x32_bf16 v[16:19], v[156:159], v[196:199], v[16:19]
  v_mfma_f32_16x16x32_bf16 v[36:39], v[156:159], v[200:203], v[36:39]
  v_mfma_f32_16x16x32_bf16 v[56:59], v[156:159], v[204:207], v[56:59]
  v_mfma_f32_16x16x32_bf16 v[76:79], v[156:159], v[208:211], v[76:79]
  v_mfma_f32_16x16x32_bf16 v[20:23], v[160:163], v[196:199], v[20:23]
  v_mfma_f32_16x16x32_bf16 v[40:43], v[160:163], v[200:203], v[40:43]
  v_mfma_f32_16x16x32_bf16 v[60:63], v[160:163], v[204:207], v[60:63]
  v_mfma_f32_16x16x32_bf16 v[80:83], v[160:163], v[208:211], v[80:83]
  v_mfma_f32_16x16x32_bf16 v[24:27], v[164:167], v[196:199], v[24:27]
  v_mfma_f32_16x16x32_bf16 v[44:47], v[164:167], v[200:203], v[44:47]
  v_mfma_f32_16x16x32_bf16 v[64:67], v[164:167], v[204:207], v[64:67]
  v_mfma_f32_16x16x32_bf16 v[84:87], v[164:167], v[208:211], v[84:87]
  v_mfma_f32_16x16x32_bf16 v[28:31], v[168:171], v[196:199], v[28:31]
  v_mfma_f32_16x16x32_bf16 v[48:51], v[168:171], v[200:203], v[48:51]
  v_mfma_f32_16x16x32_bf16 v[68:71], v[168:171], v[204:207], v[68:71]
  v_mfma_f32_16x16x32_bf16 v[88:91], v[168:171], v[208:211], v[88:91]
  v_mfma_f32_16x16x32_bf16 v[32:35], v[172:175], v[196:199], v[32:35]
  v_mfma_f32_16x16x32_bf16 v[52:55], v[172:175], v[200:203], v[52:55]
  v_mfma_f32_16x16x32_bf16 v[72:75], v[172:175], v[204:207], v[72:75]
  v_mfma_f32_16x16x32_bf16 v[92:95], v[172:175], v[208:211], v[92:95]
  s_add_u32 s62, s62, 40960
  buffer_load_dwordx4 v[96:99], v2, s[52:55], s62 offen offset:0 sc1
  buffer_load_dwordx4 v[100:103], v2, s[52:55], s62 offen offset:1024 sc1
  buffer_load_dwordx4 v[104:107], v2, s[52:55], s62 offen offset:2048 sc1
  buffer_load_dwordx4 v[108:111], v2, s[52:55], s62 offen offset:3072 sc1
  buffer_load_dwordx4 v[112:115], v3, s[52:55], s62 offen offset:0 sc1
  s_add_u32 s62, s62, 40960
  buffer_load_dwordx4 v[116:119], v2, s[52:55], s62 offen offset:0 sc1
  buffer_load_dwordx4 v[120:123], v2, s[52:55], s62 offen offset:1024 sc1
  buffer_load_dwordx4 v[124:127], v2, s[52:55], s62 offen offset:2048 sc1
  buffer_load_dwordx4 v[128:131], v2, s[52:55], s62 offen offset:3072 sc1
  buffer_load_dwordx4 v[132:135], v3, s[52:55], s62 offen offset:0 sc1
  buffer_load_dwordx4 v[200:203], v4, s[48:51], s63 offen sc1
  buffer_load_dwordx4 v[204:207], v5, s[48:51], s63 offen sc1
  buffer_load_dwordx4 v[208:211], v6, s[48:51], s63 offen sc1
  buffer_load_dwordx4 v[196:199], v255, s[48:51], s63 offen sc1
  v_and_b32 v13, 15, v1
  v_lshrrev_b32 v1, 4, v1
  v_mul_u32_u24 v3, 1280, v13
  v_lshl_add_u32 v13, v1, 3, v3
  v_lshl_add_u32 v3, v1, 4, v3
  s_mov_b32 s56, s26
  s_mov_b32 s57, s27
  s_mov_b32 s58, 0x280000
  s_mov_b32 s59, 0x20000
  s_lshl_b32 s64, s61, 2
  s_add_u32 s64, s64, s70
  s_mul_i32 s64, s64, 20480
  s_mul_i32 s66, s60, 160
  s_add_u32 s64, s64, s66
  s_waitcnt vmcnt(18)
  v_mfma_f32_16x16x32_bf16 v[16:19], v[176:179], v[212:215], v[16:19]
  v_mfma_f32_16x16x32_bf16 v[36:39], v[176:179], v[216:219], v[36:39]
  v_mfma_f32_16x16x32_bf16 v[56:59], v[176:179], v[220:223], v[56:59]
  v_mfma_f32_16x16x32_bf16 v[76:79], v[176:179], v[224:227], v[76:79]
  v_mfma_f32_16x16x32_bf16 v[20:23], v[180:183], v[212:215], v[20:23]
  v_mfma_f32_16x16x32_bf16 v[40:43], v[180:183], v[216:219], v[40:43]
  v_mfma_f32_16x16x32_bf16 v[60:63], v[180:183], v[220:223], v[60:63]
  v_mfma_f32_16x16x32_bf16 v[80:83], v[180:183], v[224:227], v[80:83]
  v_mfma_f32_16x16x32_bf16 v[24:27], v[184:187], v[212:215], v[24:27]
  v_mfma_f32_16x16x32_bf16 v[44:47], v[184:187], v[216:219], v[44:47]
  v_mfma_f32_16x16x32_bf16 v[64:67], v[184:187], v[220:223], v[64:67]
  v_mfma_f32_16x16x32_bf16 v[84:87], v[184:187], v[224:227], v[84:87]
  v_mfma_f32_16x16x32_bf16 v[28:31], v[188:191], v[212:215], v[28:31]
  v_mfma_f32_16x16x32_bf16 v[48:51], v[188:191], v[216:219], v[48:51]
  v_mfma_f32_16x16x32_bf16 v[68:71], v[188:191], v[220:223], v[68:71]
  v_mfma_f32_16x16x32_bf16 v[88:91], v[188:191], v[224:227], v[88:91]
  v_mfma_f32_16x16x32_bf16 v[32:35], v[192:195], v[212:215], v[32:35]
  v_mfma_f32_16x16x32_bf16 v[52:55], v[192:195], v[216:219], v[52:55]
  v_mfma_f32_16x16x32_bf16 v[72:75], v[192:195], v[220:223], v[72:75]
  v_mfma_f32_16x16x32_bf16 v[92:95], v[192:195], v[224:227], v[92:95]
  s_waitcnt vmcnt(9)
  v_mfma_f32_16x16x32_bf16 v[16:19], v[96:99], v[228:231], v[16:19]
  v_mfma_f32_16x16x32_bf16 v[36:39], v[96:99], v[232:235], v[36:39]
  v_mfma_f32_16x16x32_bf16 v[56:59], v[96:99], v[236:239], v[56:59]
  v_mfma_f32_16x16x32_bf16 v[76:79], v[96:99], v[240:243], v[76:79]
  v_mfma_f32_16x16x32_bf16 v[20:23], v[100:103], v[228:231], v[20:23]
  v_mfma_f32_16x16x32_bf16 v[40:43], v[100:103], v[232:235], v[40:43]
  v_mfma_f32_16x16x32_bf16 v[60:63], v[100:103], v[236:239], v[60:63]
  v_mfma_f32_16x16x32_bf16 v[80:83], v[100:103], v[240:243], v[80:83]
  v_mfma_f32_16x16x32_bf16 v[24:27], v[104:107], v[228:231], v[24:27]
  v_mfma_f32_16x16x32_bf16 v[44:47], v[104:107], v[232:235], v[44:47]
  v_mfma_f32_16x16x32_bf16 v[64:67], v[104:107], v[236:239], v[64:67]
  v_mfma_f32_16x16x32_bf16 v[84:87], v[104:107], v[240:243], v[84:87]
  v_mfma_f32_16x16x32_bf16 v[28:31], v[108:111], v[228:231], v[28:31]
  v_mfma_f32_16x16x32_bf16 v[48:51], v[108:111], v[232:235], v[48:51]
  v_mfma_f32_16x16x32_bf16 v[68:71], v[108:111], v[236:239], v[68:71]
  v_mfma_f32_16x16x32_bf16 v[88:91], v[108:111], v[240:243], v[88:91]
  v_mfma_f32_16x16x32_bf16 v[32:35], v[112:115], v[228:231], v[32:35]
  v_mfma_f32_16x16x32_bf16 v[52:55], v[112:115], v[232:235], v[52:55]
  v_mfma_f32_16x16x32_bf16 v[72:75], v[112:115], v[236:239], v[72:75]
  v_mfma_f32_16x16x32_bf16 v[92:95], v[112:115], v[240:243], v[92:95]
  s_waitcnt vmcnt(3)
  v_mfma_f32_16x16x32_bf16 v[36:39], v[116:119], v[200:203], v[36:39]
  v_mfma_f32_16x16x32_bf16 v[40:43], v[120:123], v[200:203], v[40:43]
  v_mfma_f32_16x16x32_bf16 v[44:47], v[124:127], v[200:203], v[44:47]
  v_mfma_f32_16x16x32_bf16 v[48:51], v[128:131], v[200:203], v[48:51]
  v_mfma_f32_16x16x32_bf16 v[52:55], v[132:135], v[200:203], v[52:55]
  s_waitcnt vmcnt(2)
  v_mfma_f32_16x16x32_bf16 v[56:59], v[116:119], v[204:207], v[56:59]
  s_nop 1
  ds_write_b128 v8, v[36:39] offset:0
  v_mfma_f32_16x16x32_bf16 v[60:63], v[120:123], v[204:207], v[60:63]
  ds_write_b128 v8, v[40:43] offset:1024
  v_mfma_f32_16x16x32_bf16 v[64:67], v[124:127], v[204:207], v[64:67]
  ds_write_b128 v8, v[44:47] offset:2048
  v_mfma_f32_16x16x32_bf16 v[68:71], v[128:131], v[204:207], v[68:71]
  ds_write_b128 v8, v[48:51] offset:3072
  v_mfma_f32_16x16x32_bf16 v[72:75], v[132:135], v[204:207], v[72:75]
  ds_write_b128 v8, v[52:55] offset:4096
  s_waitcnt vmcnt(1)
  v_mfma_f32_16x16x32_bf16 v[76:79], v[116:119], v[208:211], v[76:79]
  ds_write_b128 v10, v[56:59] offset:0
  v_mfma_f32_16x16x32_bf16 v[80:83], v[120:123], v[208:211], v[80:83]
  ds_write_b128 v10, v[60:63] offset:1024
  v_mfma_f32_16x16x32_bf16 v[84:87], v[124:127], v[208:211], v[84:87]
  ds_write_b128 v10, v[64:67] offset:2048
  v_mfma_f32_16x16x32_bf16 v[88:91], v[128:131], v[208:211], v[88:91]
  ds_write_b128 v10, v[68:71] offset:3072
  v_mfma_f32_16x16x32_bf16 v[92:95], v[132:135], v[208:211], v[92:95]
  ds_write_b128 v10, v[72:75] offset:4096
  s_waitcnt vmcnt(0)
  v_mfma_f32_16x16x32_bf16 v[16:19], v[116:119], v[196:199], v[16:19]
  ds_write_b128 v254, v[76:79] offset:0
  v_mfma_f32_16x16x32_bf16 v[20:23], v[120:123], v[196:199], v[20:23]
  ds_write_b128 v254, v[80:83] offset:1024
  v_mfma_f32_16x16x32_bf16 v[24:27], v[124:127], v[196:199], v[24:27]
  ds_write_b128 v254, v[84:87] offset:2048
  v_mfma_f32_16x16x32_bf16 v[28:31], v[128:131], v[196:199], v[28:31]
  ds_write_b128 v254, v[88:91] offset:3072
  v_mfma_f32_16x16x32_bf16 v[32:35], v[132:135], v[196:199], v[32:35]
  ds_write_b128 v254, v[92:95] offset:4096
  s_waitcnt lgkmcnt(0)
  s_barrier
  ds_read_b128 v[96:99], v12 offset:0
  ds_read_b128 v[100:103], v12 offset:5120
  ds_read_b128 v[104:107], v12 offset:10240
  ds_read_b128 v[108:111], v7 offset:5120
  ds_read_b128 v[112:115], v12 offset:1024
  ds_read_b128 v[116:119], v12 offset:6144
  ds_read_b128 v[120:123], v12 offset:11264
  ds_read_b128 v[124:127], v7 offset:6144
  ds_read_b128 v[128:131], v12 offset:2048
  ds_read_b128 v[132:135], v12 offset:7168
  ds_read_b128 v[136:139], v12 offset:12288
  ds_read_b128 v[140:143], v7 offset:7168
  ds_read_b128 v[144:147], v12 offset:3072
  ds_read_b128 v[148:151], v12 offset:8192
  ds_read_b128 v[152:155], v12 offset:13312
  ds_read_b128 v[156:159], v7 offset:8192
  ds_read_b128 v[160:163], v12 offset:4096
  ds_read_b128 v[164:167], v12 offset:9216
  ds_read_b128 v[168:171], v12 offset:14336
  ds_read_b128 v[172:175], v7 offset:9216
  s_waitcnt lgkmcnt(15)
  v_pk_add_f32 v[96:97], v[96:97], v[100:101]
  v_pk_add_f32 v[104:105], v[104:105], v[108:109]
  v_pk_add_f32 v[98:99], v[98:99], v[102:103]
  v_pk_add_f32 v[16:17], v[16:17], v[104:105]
  v_pk_add_f32 v[106:107], v[106:107], v[110:111]
  v_pk_add_f32 v[16:17], v[16:17], v[96:97]
  v_pk_add_f32 v[18:19], v[18:19], v[106:107]
  v_cvt_pk_bf16_f32 v40, v16, v17
  v_pk_add_f32 v[18:19], v[18:19], v[98:99]
  v_cvt_pk_bf16_f32 v41, v18, v19
  s_waitcnt lgkmcnt(12)
  v_pk_add_f32 v[112:113], v[112:113], v[116:117]
  v_pk_add_f32 v[120:121], v[120:121], v[124:125]
  v_pk_add_f32 v[114:115], v[114:115], v[118:119]
  v_pk_add_f32 v[20:21], v[20:21], v[120:121]
  v_pk_add_f32 v[122:123], v[122:123], v[126:127]
  v_pk_add_f32 v[20:21], v[20:21], v[112:113]
  v_pk_add_f32 v[22:23], v[22:23], v[122:123]
  v_cvt_pk_bf16_f32 v42, v20, v21
  v_pk_add_f32 v[22:23], v[22:23], v[114:115]
  v_cvt_pk_bf16_f32 v43, v22, v23
  buffer_store_dwordx4 v[40:43], v3, s[56:59], s64 offen offset:0
  s_waitcnt lgkmcnt(8)
  v_pk_add_f32 v[128:129], v[128:129], v[132:133]
  v_pk_add_f32 v[136:137], v[136:137], v[140:141]
  v_pk_add_f32 v[130:131], v[130:131], v[134:135]
  v_pk_add_f32 v[24:25], v[24:25], v[136:137]
  v_pk_add_f32 v[138:139], v[138:139], v[142:143]
  v_pk_add_f32 v[24:25], v[24:25], v[128:129]
  v_pk_add_f32 v[26:27], v[26:27], v[138:139]
  v_cvt_pk_bf16_f32 v44, v24, v25
  v_pk_add_f32 v[26:27], v[26:27], v[130:131]
  v_cvt_pk_bf16_f32 v45, v26, v27
  s_waitcnt lgkmcnt(4)
  v_pk_add_f32 v[144:145], v[144:145], v[148:149]
  v_pk_add_f32 v[152:153], v[152:153], v[156:157]
  v_pk_add_f32 v[146:147], v[146:147], v[150:151]
  v_pk_add_f32 v[28:29], v[28:29], v[152:153]
  v_pk_add_f32 v[154:155], v[154:155], v[158:159]
  v_pk_add_f32 v[28:29], v[28:29], v[144:145]
  v_pk_add_f32 v[30:31], v[30:31], v[154:155]
  v_cvt_pk_bf16_f32 v46, v28, v29
  v_pk_add_f32 v[30:31], v[30:31], v[146:147]
  v_cvt_pk_bf16_f32 v47, v30, v31
  buffer_store_dwordx4 v[44:47], v3, s[56:59], s64 offen offset:64
  s_waitcnt lgkmcnt(0)
  v_pk_add_f32 v[160:161], v[160:161], v[164:165]
  v_pk_add_f32 v[168:169], v[168:169], v[172:173]
  v_pk_add_f32 v[162:163], v[162:163], v[166:167]
  v_pk_add_f32 v[32:33], v[32:33], v[168:169]
  v_pk_add_f32 v[170:171], v[170:171], v[174:175]
  v_pk_add_f32 v[32:33], v[32:33], v[160:161]
  v_pk_add_f32 v[34:35], v[34:35], v[170:171]
  v_cvt_pk_bf16_f32 v48, v32, v33
  v_pk_add_f32 v[34:35], v[34:35], v[162:163]
  v_cvt_pk_bf16_f32 v49, v34, v35
  buffer_store_dwordx2 v[48:49], v13, s[56:59], s64 offen offset:128
  s_branch LA_fin
LA_fin:
LA_end:
  s_endpgm
LA_i1:
  s_sub_u32 s83, s86, 160
  s_min_u32 s83, s83, 89
  s_cmp_lg_u32 s74, 0
  s_cbranch_scc1 LA_ngo
  s_waitcnt vmcnt(3)
  buffer_store_dword v132, off, s[96:99], 0 sc1
  s_nop 0
  s_mul_i32 s62, s83, 205
  s_lshr_b32 s62, s62, 10
  s_mul_i32 s63, s62, 5
  s_sub_u32 s63, s83, s63
  s_cmp_ge_u32 s3, 4
  s_cselect_b32 s40, s22, s20
  s_cselect_b32 s41, s23, s21
  s_mov_b32 s42, 2211840
  s_mov_b32 s43, 0x20000
  s_cselect_b32 s84, 24608, 0
  s_and_b32 s64, s3, 3
  s_mul_i32 s85, s64, 3072
  s_add_u32 s84, s84, s85
  s_lshl_b32 s85, s63, 3
  s_add_u32 s85, s85, s64
  s_mul_i32 s85, s85, 55296
  s_mul_i32 s64, s62, 192
  s_add_u32 s85, s85, s64
  v_add_u32 v2, 0, v1
  v_mul_u32_u24 v3, 5462, v2
  v_lshrrev_b32 v3, 16, v3
  v_mul_u32_u24 v4, 3264, v3
  v_lshl_add_u32 v12, v2, 4, v4
  v_add_u32 v2, 64, v1
  v_mul_u32_u24 v3, 5462, v2
  v_lshrrev_b32 v3, 16, v3
  v_mul_u32_u24 v4, 3264, v3
  v_lshl_add_u32 v13, v2, 4, v4
  v_add_u32 v2, 128, v1
  v_mul_u32_u24 v3, 5462, v2
  v_lshrrev_b32 v3, 16, v3
  v_mul_u32_u24 v4, 3264, v3
  v_lshl_add_u32 v14, v2, 4, v4
  v_mul_u32_u24 v178, 80, v1
  s_lshl_b32 s75, s3, 3
  s_add_u32 s75, s75, 124032
  v_add_u32 v178, s75, v178
  v_lshrrev_b32 v179, 1, v1
  v_mul_u32_u24 v179, 80, v179
  v_and_b32 v180, 1, v1
  v_lshl_add_u32 v179, v180, 2, v179
  v_add_u32 v183, s75, v179
  v_lshrrev_b32 v179, 2, v0
  v_and_b32 v180, 3, v0
  v_and_b32 v181, 0xfc, v179
  v_add_u32 v181, v181, v180
  v_mul_u32_u24 v181, 80, v181
  v_and_b32 v182, 3, v179
  s_mov_b32 s87, 124032
  v_lshl_add_u32 v181, v182, 3, v181
  v_add_u32 v175, s87, v181
  v_lshlrev_b32 v180, 4, v180
  v_lshl_add_u32 v179, v179, 14, v180
  s_add_u32 s56, s30, 0x1800000
  s_addc_u32 s57, s31, 0
  s_mov_b32 s58, 0x500000
  s_mov_b32 s59, 0x20000
  s_mov_b32 s52, s24
  s_mov_b32 s53, s25
  s_mov_b32 s54, 0x21c000
  s_mov_b32 s55, 0x20000
  v_add_u32 v7, 0, v1
  v_mul_u32_u24 v8, 6554, v7
  v_lshrrev_b32 v8, 16, v8
  v_mul_u32_u24 v8, 1120, v8
  v_lshl_add_u32 v20, v7, 4, v8
  v_add_u32 v7, 64, v1
  v_mul_u32_u24 v8, 6554, v7
  v_lshrrev_b32 v8, 16, v8
  v_mul_u32_u24 v8, 1120, v8
  v_lshl_add_u32 v21, v7, 4, v8
  v_add_u32 v7, 128, v1
  v_mul_u32_u24 v8, 6554, v7
  v_lshrrev_b32 v8, 16, v8
  v_cmp_lt_u32 vcc, 15, v8
  v_mul_u32_u24 v8, 1120, v8
  v_lshl_add_u32 v22, v7, 4, v8
  v_add_u32 v7, 192, v1
  v_mul_u32_u24 v8, 6554, v7
  v_lshrrev_b32 v8, 16, v8
  v_mul_u32_u24 v8, 1120, v8
  v_lshl_add_u32 v23, v7, 4, v8
  v_add_u32 v7, 256, v1
  v_mul_u32_u24 v8, 6554, v7
  v_lshrrev_b32 v8, 16, v8
  v_mul_u32_u24 v8, 1120, v8
  v_lshl_add_u32 v24, v7, 4, v8
  s_sub_u32 s70, s3, 3
  s_max_i32 s70, s70, 0
  s_mul_i32 s62, s83, 5
  s_add_u32 s62, s62, s70
  s_min_u32 s62, s62, 447
  s_lshr_b32 s63, s62, 3
  s_and_b32 s64, s62, 7
  s_mul_i32 s94, s70, 5120
  s_add_u32 s94, s94, 49408
  s_lshl_b32 s92, s63, 1
  s_mul_i32 s65, s92, 205
  s_lshr_b32 s65, s65, 10
  s_mul_i32 s69, s65, 5
  s_sub_u32 s92, s92, s69
  s_sub_u32 s69, s63, 40
  s_cmp_ge_u32 s63, 40
  s_cselect_b32 s65, s69, s65
  s_cselect_b32 s92, 5, s92
  s_mul_i32 s65, s65, 27
  s_lshr_b32 s65, s65, 2
  s_add_u32 s92, s92, s65
  s_mul_i32 s92, s92, 20480
  s_lshl_b32 s93, s63, 1
  s_add_u32 s93, s93, 1
  s_mul_i32 s65, s93, 205
  s_lshr_b32 s65, s65, 10
  s_mul_i32 s69, s65, 5
  s_sub_u32 s93, s93, s69
  s_sub_u32 s69, s63, 40
  s_cmp_ge_u32 s63, 40
  s_cselect_b32 s65, s69, s65
  s_cselect_b32 s93, 6, s93
  s_mul_i32 s65, s65, 27
  s_lshr_b32 s65, s65, 2
  s_add_u32 s93, s93, s65
  s_mul_i32 s93, s93, 20480
  s_sub_u32 s93, s93, 20480
  s_mul_i32 s65, s64, 160
  s_add_u32 s92, s92, s65
  s_add_u32 s93, s93, s65
  v_mov_b32 v10, s92
  v_mov_b32 v11, s93
  v_cndmask_b32 v8, v10, v11, vcc
  v_add_u32 v22, v8, v22
  s_waitcnt vmcnt(1)
  s_branch LA_b
LA_ngo:
  s_mul_i32 s62, s83, 205
  s_lshr_b32 s62, s62, 10
  s_mul_i32 s63, s62, 5
  s_sub_u32 s63, s83, s63
  s_cmp_ge_u32 s3, 4
  s_cselect_b32 s40, s22, s20
  s_cselect_b32 s41, s23, s21
  s_mov_b32 s42, 2211840
  s_mov_b32 s43, 0x20000
  s_cselect_b32 s84, 24608, 0
  s_and_b32 s64, s3, 3
  s_mul_i32 s85, s64, 3072
  s_add_u32 s84, s84, s85
  s_lshl_b32 s85, s63, 3
  s_add_u32 s85, s85, s64
  s_mul_i32 s85, s85, 55296
  s_mul_i32 s64, s62, 192
  s_add_u32 s85, s85, s64
  v_add_u32 v2, 0, v1
  v_mul_u32_u24 v3, 5462, v2
  v_lshrrev_b32 v3, 16, v3
  v_mul_u32_u24 v4, 3264, v3
  v_lshl_add_u32 v12, v2, 4, v4
  v_add_u32 v2, 64, v1
  v_mul_u32_u24 v3, 5462, v2
  v_lshrrev_b32 v3, 16, v3
  v_mul_u32_u24 v4, 3264, v3
  v_lshl_add_u32 v13, v2, 4, v4
  v_add_u32 v2, 128, v1
  v_mul_u32_u24 v3, 5462, v2
  v_lshrrev_b32 v3, 16, v3
  v_mul_u32_u24 v4, 3264, v3
  v_lshl_add_u32 v14, v2, 4, v4
  v_mul_u32_u24 v178, 80, v1
  s_lshl_b32 s75, s3, 3
  s_add_u32 s75, s75, 124032
  v_add_u32 v178, s75, v178
  v_lshrrev_b32 v179, 1, v1
  v_mul_u32_u24 v179, 80, v179
  v_and_b32 v180, 1, v1
  v_lshl_add_u32 v179, v180, 2, v179
  v_add_u32 v183, s75, v179
  v_lshrrev_b32 v179, 2, v0
  v_and_b32 v180, 3, v0
  v_and_b32 v181, 0xfc, v179
  v_add_u32 v181, v181, v180
  v_mul_u32_u24 v181, 80, v181
  v_and_b32 v182, 3, v179
  s_mov_b32 s87, 124032
  v_lshl_add_u32 v181, v182, 3, v181
  v_add_u32 v175, s87, v181
  v_lshlrev_b32 v180, 4, v180
  v_lshl_add_u32 v179, v179, 14, v180
  s_add_u32 s56, s30, 0x1800000
  s_addc_u32 s57, s31, 0
  s_mov_b32 s58, 0x500000
  s_mov_b32 s59, 0x20000
  s_mov_b32 s52, s24
  s_mov_b32 s53, s25
  s_mov_b32 s54, 0x21c000
  s_mov_b32 s55, 0x20000
  v_add_u32 v7, 0, v1
  v_mul_u32_u24 v8, 6554, v7
  v_lshrrev_b32 v8, 16, v8
  v_mul_u32_u24 v8, 1120, v8
  v_lshl_add_u32 v20, v7, 4, v8
  v_add_u32 v7, 64, v1
  v_mul_u32_u24 v8, 6554, v7
  v_lshrrev_b32 v8, 16, v8
  v_mul_u32_u24 v8, 1120, v8
  v_lshl_add_u32 v21, v7, 4, v8
  v_add_u32 v7, 128, v1
  v_mul_u32_u24 v8, 6554, v7
  v_lshrrev_b32 v8, 16, v8
  v_cmp_lt_u32 vcc, 15, v8
  v_mul_u32_u24 v8, 1120, v8
  v_lshl_add_u32 v22, v7, 4, v8
  v_add_u32 v7, 192, v1
  v_mul_u32_u24 v8, 6554, v7
  v_lshrrev_b32 v8, 16, v8
  v_mul_u32_u24 v8, 1120, v8
  v_lshl_add_u32 v23, v7, 4, v8
  v_add_u32 v7, 256, v1
  v_mul_u32_u24 v8, 6554, v7
  v_lshrrev_b32 v8, 16, v8
  v_mul_u32_u24 v8, 1120, v8
  v_lshl_add_u32 v24, v7, 4, v8
  s_sub_u32 s70, s3, 3
  s_max_i32 s70, s70, 0
  s_mul_i32 s62, s83, 5
  s_add_u32 s62, s62, s70
  s_min_u32 s62, s62, 447
  s_lshr_b32 s63, s62, 3
  s_and_b32 s64, s62, 7
  s_mul_i32 s94, s70, 5120
  s_add_u32 s94, s94, 49408
  s_lshl_b32 s92, s63, 1
  s_mul_i32 s65, s92, 205
  s_lshr_b32 s65, s65, 10
  s_mul_i32 s69, s65, 5
  s_sub_u32 s92, s92, s69
  s_sub_u32 s69, s63, 40
  s_cmp_ge_u32 s63, 40
  s_cselect_b32 s65, s69, s65
  s_cselect_b32 s92, 5, s92
  s_mul_i32 s65, s65, 27
  s_lshr_b32 s65, s65, 2
  s_add_u32 s92, s92, s65
  s_mul_i32 s92, s92, 20480
  s_lshl_b32 s93, s63, 1
  s_add_u32 s93, s93, 1
  s_mul_i32 s65, s93, 205
  s_lshr_b32 s65, s65, 10
  s_mul_i32 s69, s65, 5
  s_sub_u32 s93, s93, s69
  s_sub_u32 s69, s63, 40
  s_cmp_ge_u32 s63, 40
  s_cselect_b32 s65, s69, s65
  s_cselect_b32 s93, 6, s93
  s_mul_i32 s65, s65, 27
  s_lshr_b32 s65, s65, 2
  s_add_u32 s93, s93, s65
  s_mul_i32 s93, s93, 20480
  s_sub_u32 s93, s93, 20480
  s_mul_i32 s65, s64, 160
  s_add_u32 s92, s92, s65
  s_add_u32 s93, s93, s65
  v_mov_b32 v10, s92
  v_mov_b32 v11, s93
  v_cndmask_b32 v8, v10, v11, vcc
  v_add_u32 v22, v8, v22
  s_waitcnt vmcnt(0)
LA_b:
  v_dot2_f32_bf16 v176, v170, s80, 0
  v_dot2_f32_bf16 v177, v170, v170, 0
  v_dot2_f32_bf16 v176, v171, s80, v176
  v_dot2_f32_bf16 v177, v171, v171, v177
  v_dot2_f32_bf16 v176, v172, s80, v176
  v_dot2_f32_bf16 v177, v172, v172, v177
  v_dot2_f32_bf16 v176, v173, s80, v176
  v_dot2_f32_bf16 v177, v173, v173, v177
  v_dot2_f32_bf16 v176, v174, s80, v176
  v_dot2_f32_bf16 v177, v174, v174, v177
  ds_write_b32 v183, v174 offset:23040
  s_nop 0
  v_add_f32_dpp v176, v176, v176 row_ror:8 row_mask:0xf bank_mask:0xf
  v_add_f32_dpp v177, v177, v177 row_ror:8 row_mask:0xf bank_mask:0xf
  ds_write_b64 v178, v[170:171] offset:12800
  ds_write_b64 v178, v[172:173] offset:17920
  v_add_f32_dpp v176, v176, v176 row_ror:4 row_mask:0xf bank_mask:0xf
  v_add_f32_dpp v177, v177, v177 row_ror:4 row_mask:0xf bank_mask:0xf
  v_lshlrev_b32 v184, 16, v170
  v_and_b32 v185, s82, v170
  v_add_f32_dpp v176, v176, v176 row_ror:2 row_mask:0xf bank_mask:0xf
  v_add_f32_dpp v177, v177, v177 row_ror:2 row_mask:0xf bank_mask:0xf
  v_lshlrev_b32 v186, 16, v171
  v_and_b32 v187, s82, v171
  v_add_f32_dpp v176, v176, v176 row_ror:1 row_mask:0xf bank_mask:0xf
  v_add_f32_dpp v177, v177, v177 row_ror:1 row_mask:0xf bank_mask:0xf
  v_lshlrev_b32 v188, 16, v172
  v_and_b32 v189, s82, v172
  v_add_f32_dpp v176, v176, v176 row_bcast:15 row_mask:0xa bank_mask:0xf
  v_add_f32_dpp v177, v177, v177 row_bcast:15 row_mask:0xa bank_mask:0xf
  v_lshlrev_b32 v190, 16, v173
  v_and_b32 v191, s82, v173
  v_add_f32_dpp v176, v176, v176 row_bcast:31 row_mask:0xc bank_mask:0xf
  v_add_f32_dpp v177, v177, v177 row_bcast:31 row_mask:0xc bank_mask:0xf
  v_lshlrev_b32 v192, 16, v174
  v_and_b32 v193, s82, v174
  v_mul_f32 v176, 0x3acccccd, v176
  v_mul_f32 v177, 0x3acccccd, v177
  v_fma_f32 v177, -v176, v176, v177
  v_cvt_pk_bf16_f32 v176, 0, v176
  v_max_f32 v177, 0, v177
  v_readlane_b32 s76, v176, 63
  v_cvt_pk_bf16_f32 v177, 0, v177
  v_add_f32 v177, 0x3727c5ac, v177
  v_pk_add_f32 v[184:185], v[184:185], s[76:77] op_sel_hi:[1,0] neg_lo:[0,1] neg_hi:[0,1]
  v_cvt_pk_bf16_f32 v177, 0, v177
  v_cvt_pk_bf16_f32 v184, 0, v184
  v_sqrt_f32 v177, v177
  v_cvt_pk_bf16_f32 v185, 0, v185
  v_pk_add_f32 v[186:187], v[186:187], s[76:77] op_sel_hi:[1,0] neg_lo:[0,1] neg_hi:[0,1]
  v_pk_add_f32 v[188:189], v[188:189], s[76:77] op_sel_hi:[1,0] neg_lo:[0,1] neg_hi:[0,1]
  v_cvt_pk_bf16_f32 v177, 0, v177
  v_cvt_pk_bf16_f32 v186, 0, v186
  v_rcp_f32 v177, v177
  v_cvt_pk_bf16_f32 v187, 0, v187
  v_cvt_pk_bf16_f32 v188, 0, v188
  v_cvt_pk_bf16_f32 v189, 0, v189
  v_readlane_b32 s78, v177, 63
  v_pk_add_f32 v[190:191], v[190:191], s[76:77] op_sel_hi:[1,0] neg_lo:[0,1] neg_hi:[0,1]
  v_pk_add_f32 v[192:193], v[192:193], s[76:77] op_sel_hi:[1,0] neg_lo:[0,1] neg_hi:[0,1]
  v_cvt_pk_bf16_f32 v190, 0, v190
  v_cvt_pk_bf16_f32 v191, 0, v191
  v_cvt_pk_bf16_f32 v192, 0, v192
  v_cvt_pk_bf16_f32 v193, 0, v193
  v_pk_mul_f32 v[184:185], v[184:185], s[78:79] op_sel_hi:[1,0]
  v_pk_mul_f32 v[186:187], v[186:187], s[78:79] op_sel_hi:[1,0]
  v_cvt_pk_bf16_f32 v184, 0, v184
  v_cvt_pk_bf16_f32 v185, 0, v185
  v_cvt_pk_bf16_f32 v186, 0, v186
  v_cvt_pk_f16_f32 v196, v184, v185
  v_cvt_pk_bf16_f32 v187, 0, v187
  v_pk_mul_f32 v[188:189], v[188:189], s[78:79] op_sel_hi:[1,0]
  v_cvt_pk_f16_f32 v197, v186, v187
  v_cvt_pk_bf16_f32 v188, 0, v188
  ds_write_b64 v178, v[196:197] offset:0
  v_cvt_pk_bf16_f32 v189, 0, v189
  v_pk_mul_f32 v[190:191], v[190:191], s[78:79] op_sel_hi:[1,0]
  v_cvt_pk_f16_f32 v198, v188, v189
  v_cvt_pk_bf16_f32 v190, 0, v190
  v_cvt_pk_bf16_f32 v191, 0, v191
  v_pk_mul_f32 v[192:193], v[192:193], s[78:79] op_sel_hi:[1,0]
  v_cvt_pk_f16_f32 v199, v190, v191
  v_cvt_pk_bf16_f32 v192, 0, v192
  ds_write_b64 v178, v[198:199] offset:5120
  v_cvt_pk_bf16_f32 v193, 0, v193
  v_cvt_pk_f16_f32 v200, v192, v193
  ds_write_b32 v183, v200 offset:10240
  s_lshl_b32 s74, s2, 6
  s_add_u32 s75, s74, 2621440
  s_add_u32 s76, s74, 2097152
  s_add_u32 s77, s74, 4194304
  s_waitcnt lgkmcnt(0)
  s_barrier
  ds_read_b64_tr_b16 v[184:185], v175 offset:0
  ds_read_b64_tr_b16 v[186:187], v175 offset:32
  s_cmp_ge_u32 s3, 2
  s_cbranch_scc1 LA_u1b
  ds_read_b64_tr_b16 v[192:193], v175 offset:10240
  ds_read_b64_tr_b16 v[194:195], v175 offset:10272
  ds_read_b64_tr_b16 v[188:189], v175 offset:12800
  ds_read_b64_tr_b16 v[190:191], v175 offset:12832
  s_waitcnt lgkmcnt(4)
  buffer_store_dwordx4 v[184:187], v179, s[56:59], s74 offen sc1
  s_waitcnt lgkmcnt(2)
  buffer_store_dwordx4 v[192:195], v179, s[56:59], s76 offen sc1
  s_cmp_lg_u32 s3, 0
  s_cbranch_scc1 LA_u0b
  buffer_load_dword v130, off, s[96:99], 0 sc1
  s_waitcnt lgkmcnt(0)
  buffer_store_dwordx4 v[188:191], v179, s[56:59], s75 offen sc1
  s_branch LA_u3b
LA_u0b:
  s_waitcnt lgkmcnt(0)
  buffer_store_dwordx4 v[188:191], v179, s[56:59], s75 offen sc1
  s_branch LA_u3b
LA_u1b:
  ds_read_b64_tr_b16 v[188:189], v175 offset:12800
  ds_read_b64_tr_b16 v[190:191], v175 offset:12832
  s_cmp_ge_u32 s3, 4
  s_cbranch_scc1 LA_u2b
  ds_read_b64_tr_b16 v[192:193], v175 offset:20480
  ds_read_b64_tr_b16 v[194:195], v175 offset:20512
  s_waitcnt lgkmcnt(4)
  buffer_store_dwordx4 v[184:187], v179, s[56:59], s74 offen sc1
  s_waitcnt lgkmcnt(2)
  buffer_store_dwordx4 v[188:191], v179, s[56:59], s75 offen sc1
  s_waitcnt lgkmcnt(0)
  buffer_store_dwordx4 v[192:195], v179, s[56:59], s77 offen sc1
  s_branch LA_u3b
LA_u2b:
  s_waitcnt lgkmcnt(2)
  buffer_store_dwordx4 v[184:187], v179, s[56:59], s74 offen sc1
  s_waitcnt lgkmcnt(0)
  buffer_store_dwordx4 v[188:191], v179, s[56:59], s75 offen sc1
LA_u3b:
  s_and_b32 s78, s3, 6
  s_cmp_eq_u32 s78, 2
  s_cbranch_scc1 LS_wp
  s_waitcnt vmcnt(1)
LS_wp:
  s_waitcnt vmcnt(2)
  s_barrier
  s_cmp_lg_u32 s3, 0
  s_cbranch_scc1 LS_skipp
  s_mov_b32 s79, 0
LS_gop:
  v_readfirstlane_b32 s78, v130
  s_cmp_eq_u32 s78, 1
  s_cbranch_scc1 LS_okp
  buffer_load_dword v130, off, s[96:99], 0 sc1
  s_add_u32 s79, s79, 1
  s_cmp_lt_u32 s79, 100000
  s_waitcnt vmcnt(0)
  s_cbranch_scc1 LS_gop
LS_okp:
  s_and_b32 s78, s2, 15
  s_lshl_b32 s78, s78, 10
  s_mov_b64 exec, 255
  buffer_atomic_add v132, v131, s[36:39], s78 offen offset:0 sc1
  s_mov_b64 exec, -1
LS_skipp:
  s_cmp_ge_u32 s86, 250
  s_cbranch_scc1 LA_r2
  s_add_u32 m0, s84, 0
  s_nop 0
  buffer_load_dwordx4 v12, s[40:43], s85 offen lds
  s_cmp_lg_u32 s3, 0
  s_cbranch_scc1 LX_ap
  s_waitcnt vmcnt(2)
  s_branch LX_bp
LX_ap:
  s_waitcnt vmcnt(1)
LX_bp:
  s_barrier
  s_cmp_lg_u32 s3, 1
  s_cbranch_scc1 LX_cp
  s_and_b32 s78, s2, 15
  s_lshl_b32 s78, s78, 10
  s_mov_b64 exec, 255
  buffer_atomic_add v133, v131, s[36:39], s78 offen offset:12 sc1
  s_mov_b64 exec, -1
LX_cp:
  s_add_u32 m0, s84, 1024
  s_nop 0
  buffer_load_dwordx4 v13, s[40:43], s85 offen lds
  s_add_u32 m0, s84, 2048
  s_nop 0
  buffer_load_dwordx4 v14, s[40:43], s85 offen lds
  s_add_u32 s85, s85, 221184
  s_add_u32 m0, s84, 12288
  s_nop 0
  buffer_load_dwordx4 v12, s[40:43], s85 offen lds
  s_add_u32 m0, s84, 13312
  s_nop 0
  buffer_load_dwordx4 v13, s[40:43], s85 offen lds
  s_add_u32 m0, s84, 14336
  s_nop 0
  buffer_load_dwordx4 v14, s[40:43], s85 offen lds
  s_mul_i32 s62, s83, 205
  s_lshr_b32 s62, s62, 10
  s_mul_i32 s63, s62, 5
  s_sub_u32 s63, s83, s63
  s_add_u32 s44, s30, 0x300000
  s_addc_u32 s45, s31, 0
  s_mov_b32 s46, 0x453000
  s_mov_b32 s47, 0x20000
  v_bfe_u32 v3, v1, 4, 1
  v_mul_u32_u24 v3, 24608, v3
  v_lshrrev_b32 v4, 5, v1
  v_bfe_u32 v5, v1, 2, 2
  v_lshl_add_u32 v4, v4, 3, v5
  v_mul_u32_u24 v4, 192, v4
  v_add_u32 v3, v3, v4
  v_and_b32 v4, 1, v1
  v_lshl_add_u32 v3, v4, 4, v3
  v_bfe_u32 v4, v1, 1, 1
  v_lshl_add_u32 v3, v4, 3, v3
  s_lshl_b32 s65, s3, 5
  v_add_u32 v3, s65, v3
  s_mul_i32 s64, s62, 6
  s_add_u32 s64, s64, s3
  s_mul_i32 s64, s64, 41984
  s_lshl_b32 s65, s63, 13
  s_add_u32 s65, s65, s64
  v_lshlrev_b32 v4, 4, v1
  v_mov_b32 v28, s80
  v_mov_b32 v29, s80
  v_mov_b32 v30, s80
  v_mov_b32 v31, s80
  s_waitcnt vmcnt(3)
  s_barrier
  s_cmp_ge_u32 s3, 6
  s_cbranch_scc1 LA_p13h
  ds_read_b64_tr_b16 v[32:33], v3 offset:0
  ds_read_b64_tr_b16 v[34:35], v3 offset:768
  ds_read_b64_tr_b16 v[36:37], v3 offset:3072
  ds_read_b64_tr_b16 v[38:39], v3 offset:3840
  ds_read_b64_tr_b16 v[40:41], v3 offset:6144
  ds_read_b64_tr_b16 v[42:43], v3 offset:6912
  ds_read_b64_tr_b16 v[44:45], v3 offset:9216
  ds_read_b64_tr_b16 v[46:47], v3 offset:9984
  s_waitcnt lgkmcnt(6)
  v_mfma_f32_32x32x16_bf16 v[64:79], v[28:31], v[32:35], 0
  buffer_store_dwordx4 v[32:35], v4, s[44:47], s65 offen offset:0 sc1
  s_waitcnt lgkmcnt(4)
  v_mfma_f32_32x32x16_bf16 v[64:79], v[28:31], v[36:39], v[64:79]
  buffer_store_dwordx4 v[36:39], v4, s[44:47], s65 offen offset:1024 sc1
  s_waitcnt lgkmcnt(2)
  v_mfma_f32_32x32x16_bf16 v[64:79], v[28:31], v[40:43], v[64:79]
  buffer_store_dwordx4 v[40:43], v4, s[44:47], s65 offen offset:2048 sc1
  s_waitcnt lgkmcnt(0)
  v_mfma_f32_32x32x16_bf16 v[64:79], v[28:31], v[44:47], v[64:79]
  buffer_store_dwordx4 v[44:47], v4, s[44:47], s65 offen offset:3072 sc1
  s_cmp_ge_u32 s3, 6
  s_cbranch_scc1 LA_p13w
  s_waitcnt vmcnt(4)
  s_branch LA_p13x
LA_p13h:
LA_p13w:
  s_waitcnt vmcnt(0)
LA_p13x:
  s_barrier
  s_cmp_ge_u32 s3, 6
  s_cbranch_scc1 LA_p13
  ds_read_b64_tr_b16 v[48:49], v3 offset:12288
  ds_read_b64_tr_b16 v[50:51], v3 offset:13056
  ds_read_b64_tr_b16 v[52:53], v3 offset:15360
  ds_read_b64_tr_b16 v[54:55], v3 offset:16128
  ds_read_b64_tr_b16 v[56:57], v3 offset:18432
  ds_read_b64_tr_b16 v[58:59], v3 offset:19200
  ds_read_b64_tr_b16 v[60:61], v3 offset:21504
  ds_read_b64_tr_b16 v[62:63], v3 offset:22272
  s_waitcnt lgkmcnt(6)
  v_mfma_f32_32x32x16_bf16 v[64:79], v[28:31], v[48:51], v[64:79]
  s_add_u32 s65, s65, 4096
  buffer_store_dwordx4 v[48:51], v4, s[44:47], s65 offen offset:0 sc1
  s_waitcnt lgkmcnt(4)
  v_mfma_f32_32x32x16_bf16 v[64:79], v[28:31], v[52:55], v[64:79]
  buffer_store_dwordx4 v[52:55], v4, s[44:47], s65 offen offset:1024 sc1
  s_waitcnt lgkmcnt(2)
  v_mfma_f32_32x32x16_bf16 v[64:79], v[28:31], v[56:59], v[64:79]
  buffer_store_dwordx4 v[56:59], v4, s[44:47], s65 offen offset:2048 sc1
  s_waitcnt lgkmcnt(0)
  v_mfma_f32_32x32x16_bf16 v[64:79], v[28:31], v[60:63], v[64:79]
  buffer_store_dwordx4 v[60:63], v4, s[44:47], s65 offen offset:3072 sc1
  s_nop 10
  v_cvt_pk_bf16_f32 v5, v64, v64
  v_lshlrev_b32 v6, 16, v5
  v_sub_f32 v12, v64, v6
  v_lshrrev_b32 v6, 16, v6
  v_cvt_pk_bf16_f32 v5, 0, v12
  v_or_b32 v12, v5, v6
  v_mov_b32 v13, 0
  v_mov_b32 v14, 0
  v_mov_b32 v15, 0
  s_lshl_b32 s65, s63, 2
  s_add_u32 s65, s65, s64
  s_add_u32 s65, s65, 40960
  s_mov_b32 exec_hi, 0
  s_cmp_eq_u32 s63, 4
  s_cbranch_scc1 LA_p13b
  buffer_store_dword v12, v4, s[44:47], s65 offen sc1
  s_branch LA_p13c
LA_p13b:
  buffer_store_dwordx4 v[12:15], v4, s[44:47], s65 offen offset:496 sc1
LA_p13c:
  s_mov_b32 exec_hi, -1
LA_p13:
  s_branch LA_r3
LA_r2:
  s_cmp_lg_u32 s3, 0
  s_cbranch_scc1 LX_an
  s_waitcnt vmcnt(1)
  s_branch LX_bn
LX_an:
  s_waitcnt vmcnt(0)
LX_bn:
  s_barrier
  s_cmp_lg_u32 s3, 1
  s_cbranch_scc1 LX_cn
  s_and_b32 s78, s2, 15
  s_lshl_b32 s78, s78, 10
  s_mov_b64 exec, 255
  buffer_atomic_add v133, v131, s[36:39], s78 offen offset:12 sc1
  s_mov_b64 exec, -1
LX_cn:
LA_r3:
  s_waitcnt vmcnt(0)
LA_r4:
  s_lshr_b32 s78, s2, 3
  s_and_b32 s78, s78, 7
  s_lshl_b32 s78, s78, 7
  v_lshl_add_u32 v246, v1, 10, s78
  s_barrier
  s_cmp_lg_u32 s3, 0
  s_cbranch_scc1 LA_np
  s_and_b32 s78, s86, 15
  s_lshl_b32 s78, s78, 10
  s_mov_b64 exec, 255
  buffer_atomic_add v132, v131, s[36:39], s78 offen offset:8 sc1
  s_mov_b64 exec, -1
LA_np:
  s_cmp_lg_u32 s3, 1
  s_cbranch_scc1 LA_pe
  s_and_b32 s35, s2, 1
  s_lshl_b32 s32, s35, 3
  s_bfe_u32 s18, s2, 0x30003
  s_add_u32 s32, s32, s18
  s_bfe_u32 s33, s2, 0x20001
  s_lshl_b32 s33, s33, 2
  s_lshr_b32 s35, s2, 6
  s_add_u32 s33, s33, s35
  s_add_u32 s18, s18, s35
  s_and_b32 s18, s18, 3
  s_mul_i32 s18, s18, 0
  s_mul_i32 s34, s33, 27
  s_lshr_b32 s34, s34, 2
  s_mul_i32 s34, s34, 41984
  s_add_u32 s40, s30, 0x10000
  s_addc_u32 s41, s31, 0
  s_mov_b32 s42, 0x280000
  s_mov_b32 s43, 0x20000
  s_add_u32 s44, s30, 0x300000
  s_addc_u32 s45, s31, 0
  s_mov_b32 s46, 0x453000
  s_mov_b32 s47, 0x20000
  s_mov_b64 exec, 65535
  v_mov_b32 v244, 0
  buffer_atomic_add v244, v246, s[36:39], 0 offen offset:8 sc0 sc1
  s_mov_b64 exec, -1
  v_lshlrev_b32 v2, 4, v1
  v_add_u32 v4, s34, v2
  v_add_u32 v5, 41984, v4
  s_mov_b32 s60, 0
  s_mov_b32 s79, 0
LP_loopQ:
  s_waitcnt vmcnt(0)
  v_cmp_gt_u32 vcc, 6, v244
  s_and_b32 s78, vcc_lo, 65535
  s_cbranch_scc0 LP_doneQ
  s_mov_b64 exec, 65535
  v_mov_b32 v244, 0
  buffer_atomic_add v244, v246, s[36:39], 0 offen offset:8 sc0 sc1
  s_mov_b64 exec, -1
  s_add_u32 s79, s79, 1
  s_cmp_lt_u32 s79, 100000
  s_cbranch_scc1 LP_loopQ
  s_waitcnt vmcnt(0)
LP_doneQ:
  s_mov_b32 m0, 8192
  s_nop 0
  buffer_load_dwordx4 v4, s[44:47], s60 offen offset:0 sc1 lds
  buffer_load_dwordx4 v4, s[44:47], s60 offen offset:1024 sc1 lds
  buffer_load_dwordx4 v4, s[44:47], s60 offen offset:2048 sc1 lds
  buffer_load_dwordx4 v4, s[44:47], s60 offen offset:3072 sc1 lds
  s_mov_b32 m0, 12288
  s_nop 0
  buffer_load_dwordx4 v5, s[44:47], s60 offen offset:0 sc1 lds
  buffer_load_dwordx4 v5, s[44:47], s60 offen offset:1024 sc1 lds
  buffer_load_dwordx4 v5, s[44:47], s60 offen offset:2048 sc1 lds
  buffer_load_dwordx4 v5, s[44:47], s60 offen offset:3072 sc1 lds
  s_add_u32 s60, s60, 4096
  s_mov_b32 m0, 16384
  s_nop 0
  buffer_load_dwordx4 v4, s[44:47], s60 offen offset:0 sc1 lds
  buffer_load_dwordx4 v4, s[44:47], s60 offen offset:1024 sc1 lds
  buffer_load_dwordx4 v4, s[44:47], s60 offen offset:2048 sc1 lds
  buffer_load_dwordx4 v4, s[44:47], s60 offen offset:3072 sc1 lds
  s_mov_b32 m0, 20480
  s_nop 0
  buffer_load_dwordx4 v5, s[44:47], s60 offen offset:0 sc1 lds
  buffer_load_dwordx4 v5, s[44:47], s60 offen offset:1024 sc1 lds
  buffer_load_dwordx4 v5, s[44:47], s60 offen offset:2048 sc1 lds
  buffer_load_dwordx4 v5, s[44:47], s60 offen offset:3072 sc1 lds
  s_add_u32 s60, s60, 4096
  s_mov_b32 m0, 24576
  s_nop 0
  buffer_load_dwordx4 v4, s[44:47], s60 offen offset:0 sc1 lds
  buffer_load_dwordx4 v4, s[44:47], s60 offen offset:1024 sc1 lds
  buffer_load_dwordx4 v4, s[44:47], s60 offen offset:2048 sc1 lds
  buffer_load_dwordx4 v4, s[44:47], s60 offen offset:3072 sc1 lds
  s_mov_b32 m0, 28672
  s_nop 0
  buffer_load_dwordx4 v5, s[44:47], s60 offen offset:0 sc1 lds
  buffer_load_dwordx4 v5, s[44:47], s60 offen offset:1024 sc1 lds
  buffer_load_dwordx4 v5, s[44:47], s60 offen offset:2048 sc1 lds
  buffer_load_dwordx4 v5, s[44:47], s60 offen offset:3072 sc1 lds
  s_add_u32 s60, s60, 4096
  s_mov_b32 m0, 32768
  s_nop 0
  buffer_load_dwordx4 v4, s[44:47], s60 offen offset:0 sc1 lds
  buffer_load_dwordx4 v4, s[44:47], s60 offen offset:1024 sc1 lds
  buffer_load_dwordx4 v4, s[44:47], s60 offen offset:2048 sc1 lds
  buffer_load_dwordx4 v4, s[44:47], s60 offen offset:3072 sc1 lds
  s_mov_b32 m0, 36864
  s_nop 0
  buffer_load_dwordx4 v5, s[44:47], s60 offen offset:0 sc1 lds
  buffer_load_dwordx4 v5, s[44:47], s60 offen offset:1024 sc1 lds
  buffer_load_dwordx4 v5, s[44:47], s60 offen offset:2048 sc1 lds
  buffer_load_dwordx4 v5, s[44:47], s60 offen offset:3072 sc1 lds
  s_add_u32 s60, s60, 4096
  s_mov_b32 m0, 40960
  s_nop 0
  buffer_load_dwordx4 v4, s[44:47], s60 offen offset:0 sc1 lds
  buffer_load_dwordx4 v4, s[44:47], s60 offen offset:1024 sc1 lds
  buffer_load_dwordx4 v4, s[44:47], s60 offen offset:2048 sc1 lds
  buffer_load_dwordx4 v4, s[44:47], s60 offen offset:3072 sc1 lds
  s_mov_b32 m0, 45056
  s_nop 0
  buffer_load_dwordx4 v5, s[44:47], s60 offen offset:0 sc1 lds
  buffer_load_dwordx4 v5, s[44:47], s60 offen offset:1024 sc1 lds
  buffer_load_dwordx4 v5, s[44:47], s60 offen offset:2048 sc1 lds
  buffer_load_dwordx4 v5, s[44:47], s60 offen offset:3072 sc1 lds
  s_branch LA_ped
LA_pe:
  s_cmp_ge_u32 s86, 250
  s_cbranch_scc1 LA_p2
  s_cmp_lt_u32 s3, 3
  s_cbranch_scc1 LA_p2
  s_mov_b32 m0, s94
  s_nop 0
  buffer_load_dwordx4 v20, s[52:55], s92 offen lds
  s_add_u32 m0, m0, 1024
  s_nop 0
  buffer_load_dwordx4 v21, s[52:55], s92 offen lds
  s_add_u32 m0, m0, 1024
  s_nop 0
  buffer_load_dwordx4 v22, s[52:55], 0 offen lds
  s_add_u32 m0, m0, 1024
  s_nop 0
  buffer_load_dwordx4 v23, s[52:55], s93 offen lds
  s_add_u32 m0, m0, 1024
  s_nop 0
  buffer_load_dwordx4 v24, s[52:55], s93 offen lds
  s_cmp_lt_u32 s3, 3
  s_cbranch_scc1 LA_p2
  s_sub_u32 s70, s3, 3
  s_mul_i32 s62, s83, 5
  s_add_u32 s62, s62, s70
  s_cmp_ge_u32 s62, 448
  s_cbranch_scc1 LA_p2
  s_lshr_b32 s63, s62, 3
  s_and_b32 s64, s62, 7
  s_mul_i32 s68, s70, 5120
  s_add_u32 s68, s68, 49408
  s_add_u32 s44, s30, 0x780000
  s_addc_u32 s45, s31, 0
  s_mov_b32 s46, 0x230000
  s_mov_b32 s47, 0x20000
  v_lshrrev_b32 v7, 4, v1
  v_bfe_u32 v8, v1, 2, 2
  v_lshl_add_u32 v7, v7, 3, v8
  v_mul_u32_u24 v7, 160, v7
  v_add_u32 v7, s68, v7
  v_and_b32 v8, 3, v1
  v_lshl_add_u32 v11, v8, 3, v7
  v_lshl_add_u32 v8, v8, 4, v7
  s_mul_i32 s65, s64, 56
  s_add_u32 s65, s65, s63
  s_mul_i32 s65, s65, 5120
  v_lshlrev_b32 v10, 4, v1
  s_waitcnt vmcnt(0)
  ds_read_b64_tr_b16 v[64:65], v8 offset:0
  ds_read_b64_tr_b16 v[66:67], v8 offset:640
  ds_read_b64_tr_b16 v[68:69], v8 offset:8
  ds_read_b64_tr_b16 v[70:71], v8 offset:648
  ds_read_b64_tr_b16 v[72:73], v8 offset:64
  ds_read_b64_tr_b16 v[74:75], v8 offset:704
  ds_read_b64_tr_b16 v[76:77], v8 offset:72
  ds_read_b64_tr_b16 v[78:79], v8 offset:712
  ds_read_b64_tr_b16 v[80:81], v11 offset:128
  ds_read_b64_tr_b16 v[82:83], v11 offset:768
  s_waitcnt lgkmcnt(8)
  buffer_store_dwordx4 v[64:67], v10, s[44:47], s65 offen offset:0 sc1
  s_waitcnt lgkmcnt(6)
  buffer_store_dwordx4 v[68:71], v10, s[44:47], s65 offen offset:1024 sc1
  s_waitcnt lgkmcnt(4)
  buffer_store_dwordx4 v[72:75], v10, s[44:47], s65 offen offset:2048 sc1
  s_waitcnt lgkmcnt(2)
  buffer_store_dwordx4 v[76:79], v10, s[44:47], s65 offen offset:3072 sc1
  s_waitcnt lgkmcnt(0)
  s_add_u32 s65, s65, 4096
  buffer_store_dwordx4 v[80:83], v10, s[44:47], s65 offen offset:0 sc1
LA_p2:
  s_and_b32 s35, s2, 1
  s_lshl_b32 s32, s35, 3
  s_bfe_u32 s18, s2, 0x30003
  s_add_u32 s32, s32, s18
  s_bfe_u32 s33, s2, 0x20001
  s_lshl_b32 s33, s33, 2
  s_lshr_b32 s35, s2, 6
  s_add_u32 s33, s33, s35
  s_add_u32 s18, s18, s35
  s_and_b32 s18, s18, 3
  s_mul_i32 s18, s18, 0
  s_mul_i32 s34, s33, 27
  s_lshr_b32 s34, s34, 2
  s_mul_i32 s34, s34, 41984
  s_add_u32 s40, s30, 0x10000
  s_addc_u32 s41, s31, 0
  s_mov_b32 s42, 0x280000
  s_mov_b32 s43, 0x20000
  s_add_u32 s44, s30, 0x300000
  s_addc_u32 s45, s31, 0
  s_mov_b32 s46, 0x453000
  s_mov_b32 s47, 0x20000
LA_ped:
  s_waitcnt vmcnt(0)
  s_barrier
  s_cmp_lg_u32 s3, 0
  s_cbranch_scc1 LA_nh
  s_and_b32 s78, s86, 15
  s_lshl_b32 s78, s78, 10
  s_mov_b64 exec, 255
  buffer_atomic_add v132, v131, s[36:39], s78 offen offset:12 sc1
  s_mov_b64 exec, -1
LA_nh:
  s_branch L_ffn
L_text_end:
.section .rodata,"a"
.p2align 6
.amdhsa_kernel sequential_preLN__ssm_conv_s4d__glu_gated_swiglu__prompt_kernel
  .amdhsa_next_free_vgpr 256
  .amdhsa_next_free_sgpr 102
  .amdhsa_accum_offset 256
  .amdhsa_group_segment_fixed_size 0
  .amdhsa_kernarg_size 112
  .amdhsa_user_sgpr_count 2
  .amdhsa_user_sgpr_kernarg_segment_ptr 1
  .amdhsa_system_sgpr_workgroup_id_x 1
.end_amdhsa_kernel
```
